```python
import torch

def _softmax(x, axis=-1):
    return torch.softmax(x, dim=axis)
def _gelu(x):
    return torch.nn.functional.gelu(x, approximate="tanh")
def _silu(x):
    return torch.nn.functional.silu(x)
def _sigmoid(x):
    return torch.sigmoid(x)
def _layernorm(x, axis=-1, eps=1e-5):
    m = x.mean(dim=axis, keepdim=True)
    v = x.var(dim=axis, keepdim=True, unbiased=False)
    return (x - m) / torch.sqrt(v + eps)
def _scatter_add(tgt, idx, src, axis=0):
    return tgt.clone().index_add_(axis, idx, src)
def _segment_sum(src, seg, n):
    out = torch.zeros((n,) + src.shape[1:], dtype=src.dtype)
    return out.index_add_(0, seg, src)
def _pad(x, pw):
    flat = tuple(v for pair in reversed(pw) for v in pair)
    return torch.nn.functional.pad(x, flat)

kernel_name = 'interleave_layers__mha_block__dense_activation_mish__prompt'

def setup_inputs():

    _w = (lambda a: (lambda t: t.to(torch.bfloat16) if t.is_floating_point() else t)(torch.as_tensor(a)))
    def _A_setup():
        B, S, D, H = 1, 2048, 512, 32
        return {
            "x": _w((lambda *s: torch.randn(*s, dtype=torch.bfloat16) * 0.05)(B, S, D)),
            "wqkv": _w((lambda *s: torch.randn(*s, dtype=torch.bfloat16) * 0.05)(D, 3 * D)),
            "wo": _w((lambda *s: torch.randn(*s, dtype=torch.bfloat16) * 0.05)(D, D)),
        }
    _A_in = _A_setup()

    def _B_setup():
        B, S, D, F = 1, 2048, 512, 1376
        return {
            "x": _w((lambda *s: torch.randn(*s, dtype=torch.bfloat16) * 0.05)(B, S, D)),
            "w1": _w((lambda *s: torch.randn(*s, dtype=torch.bfloat16) * 1.6)(D, F) * (D ** -0.5)),
            "b1": _w((lambda *s: torch.randn(*s, dtype=torch.bfloat16) * 0.2)(F)),
            "w2": _w((lambda *s: torch.randn(*s, dtype=torch.bfloat16) * 0.2)(F, D) * (F ** -0.5)),
        }
    _B_in = _B_setup()

    return {
        "A_x": _A_in["x"],
        "A_wqkv": _A_in["wqkv"],
        "A_wo": _A_in["wo"],
        "B_x": _B_in["x"],
        "B_w1": _B_in["w1"],
        "B_b1": _B_in["b1"],
        "B_w2": _B_in["w2"],
    }

def reference(A_x, A_wqkv, A_wo, B_x, B_w1, B_b1, B_w2):
    def _A_ref(x, wqkv, wo):
        B, S, D = x.shape
        H = 32
        Dh = D // H
        qkv = (lambda x, *d: x.permute(*d))((x @ wqkv).reshape(B, S, 3, H, Dh), 2, 0, 3, 1, 4)
        q, k, v = qkv[0], qkv[1], qkv[2]
        scores = torch.einsum("bhqd,bhkd->bhqk", q, k) * (Dh ** -0.5)
        p = _softmax(scores, axis=-1)
        o = torch.einsum("bhqk,bhkd->bhqd", p, v)
        return (lambda x, *d: x.permute(*d))(o, 0, 2, 1, 3).reshape(B, S, D) @ wo

    def _B_ref(x, w1, b1, w2):
        h = torch.einsum("bsd,df->bsf", x, w1) + b1
        sp = torch.log1p(torch.exp(-torch.abs(h))) + torch.where(h > 0, h, torch.zeros_like(h))
        act = h * torch.tanh(sp)
        return torch.einsum("bsf,fd->bsd", act, w2)

    x = A_x
    x = x + _A_ref(_layernorm(x, axis=-1), A_wqkv, A_wo)
    x = x + _B_ref(_layernorm(x, axis=-1), B_w1, B_b1, B_w2)
    x = x + _A_ref(_layernorm(x, axis=-1), A_wqkv, A_wo)
    x = x + _B_ref(_layernorm(x, axis=-1), B_w1, B_b1, B_w2)
    return x
```

```asm
; @launch grid=(256,1,1) block=(512,1,1) lds=163840
.amdgcn_target "amdgcn-amd-amdhsa--gfx950"
.text
.p2align 8
code_start:
.globl interleave_layers__mha_block__dense_activation_mish__prompt_kernel
.p2align 8
.type interleave_layers__mha_block__dense_activation_mish__prompt_kernel,@function
interleave_layers__mha_block__dense_activation_mish__prompt_kernel:
    s_cmp_ge_u32 s2, 256
    s_cbranch_scc1 mega_end
    s_load_dwordx8 s[64:71], s[0:1], 0
    s_getpc_b64 s[30:31]
pc_top:
    v_lshlrev_b32 v8, 7, v0
    v_min_u32 v8, code_end-pc_top-4, v8
    global_load_dword v8, v8, s[30:31]
    s_load_dwordx8 s[72:79], s[0:1], 32
    s_load_dwordx4 s[80:83], s[0:1], 64
    v_lshrrev_b32 v2, 6, v0
    v_and_b32 v1, 63, v0
    v_readfirstlane_b32 s20, v2
    v_lshlrev_b32 v4, 4, v1
    v_lshrrev_b32 v5, 5, v1
    v_lshlrev_b32 v6, 2, v1
    s_and_b32 s23, s2, 7
    s_lshr_b32 s24, s2, 3
    s_and_b32 s21, s20, 3
    s_lshl_b32 s92, s23, 1
    s_and_b32 s93, s24, 1
    s_add_u32 s92, s92, s93
    s_lshl_b32 s92, s92, 2
    s_add_u32 s92, s92, s21
    s_lshr_b32 s93, s24, 1
    s_mov_b32 s22, 0
    s_mov_b32 s3, 0
    s_mov_b32 s29, 0
    s_mov_b32 s100, 4
    s_movk_i32 s101, 0x70
    s_mov_b32 s98, 0x70000000
    s_cmp_lt_u32 s20, 4
    s_cbranch_scc1 Lp0comp_1
    v_add_u32 v2, 0, v1
    v_mul_u32_u24 v3, 43691, v2
    v_lshrrev_b32 v3, 19, v3
    v_mul_u32_u24 v16, 12, v3
    v_sub_u32 v2, v2, v16
    v_mul_u32_u24 v3, 3072, v3
    v_lshl_add_u32 v16, v2, 4, v3
    v_add_u32 v2, 64, v1
    v_mul_u32_u24 v3, 43691, v2
    v_lshrrev_b32 v3, 19, v3
    v_mul_u32_u24 v17, 12, v3
    v_sub_u32 v2, v2, v17
    v_mul_u32_u24 v3, 3072, v3
    v_lshl_add_u32 v17, v2, 4, v3
    v_subrev_u32 v17, 1024, v17
    v_add_u32 v2, 128, v1
    v_mul_u32_u24 v3, 43691, v2
    v_lshrrev_b32 v3, 19, v3
    v_mul_u32_u24 v18, 12, v3
    v_sub_u32 v2, v2, v18
    v_mul_u32_u24 v3, 3072, v3
    v_lshl_add_u32 v18, v2, 4, v3
    v_subrev_u32 v18, 2048, v18
    s_mul_i32 s32, s93, 192
    s_mul_i32 s33, s21, 98304
    s_add_u32 s32, s32, s33
    s_mul_i32 s33, s21, 6144
    s_add_u32 s33, s33, 65536
    v_lshrrev_b32 v2, 4, v1
    v_and_b32 v3, 15, v1
    v_xor_b32 v3, v3, v2
    v_lshlrev_b32 v3, 4, v3
    v_lshl_add_u32 v20, v2, 10, v3
    v_xor_b32 v21, 64, v20
    v_xor_b32 v22, 128, v20
    v_xor_b32 v23, 192, v20
    s_lshl_b32 s30, s92, 15
    s_lshl_b32 s31, s21, 13
    s_add_u32 s34, s23, 0
    s_and_b32 s34, s34, 3
    s_lshl_b32 s35, s34, 8
    s_add_u32 s36, s30, s35
    s_mul_i32 s35, s34, 393216
    s_add_u32 s40, s32, s35
    s_add_u32 s34, s23, 1
    s_and_b32 s34, s34, 3
    s_lshl_b32 s35, s34, 8
    s_add_u32 s37, s30, s35
    s_mul_i32 s35, s34, 393216
    s_add_u32 s41, s32, s35
    s_add_u32 s34, s23, 2
    s_and_b32 s34, s34, 3
    s_lshl_b32 s35, s34, 8
    s_add_u32 s38, s30, s35
    s_mul_i32 s35, s34, 393216
    s_add_u32 s42, s32, s35
    s_add_u32 s34, s23, 3
    s_and_b32 s34, s34, 3
    s_lshl_b32 s35, s34, 8
    s_add_u32 s39, s30, s35
    s_mul_i32 s35, s34, 393216
    s_add_u32 s43, s32, s35
    s_waitcnt lgkmcnt(0)
    s_mov_b32 s4, s64
    s_mov_b32 s5, s65
    s_mov_b32 s6, 0x200000
    s_mov_b32 s7, 0x00020000
    s_mov_b32 s8, s66
    s_mov_b32 s9, s67
    s_mov_b32 s10, 0x180000
    s_mov_b32 s11, 0x00020000
    s_add_u32 m0, s31, 65536
    s_add_u32 s34, s39, 0
    buffer_load_dwordx4 v20, s[4:7], s34 offen lds
    s_add_u32 m0, s31, 66560
    s_add_u32 s34, s39, 4096
    buffer_load_dwordx4 v21, s[4:7], s34 offen lds
    s_add_u32 m0, s31, 67584
    s_add_u32 s34, s39, 8192
    buffer_load_dwordx4 v22, s[4:7], s34 offen lds
    s_add_u32 m0, s31, 68608
    s_add_u32 s34, s39, 12288
    buffer_load_dwordx4 v23, s[4:7], s34 offen lds
    s_add_u32 m0, s31, 69632
    s_add_u32 s34, s39, 16384
    buffer_load_dwordx4 v20, s[4:7], s34 offen lds
    s_add_u32 m0, s31, 70656
    s_add_u32 s34, s39, 20480
    buffer_load_dwordx4 v21, s[4:7], s34 offen lds
    s_add_u32 m0, s31, 71680
    s_add_u32 s34, s39, 24576
    buffer_load_dwordx4 v22, s[4:7], s34 offen lds
    s_add_u32 m0, s31, 72704
    s_add_u32 s34, s39, 28672
    buffer_load_dwordx4 v23, s[4:7], s34 offen lds
    s_add_u32 m0, s33, 73728
    s_add_u32 s35, s43, 0
    buffer_load_dwordx4 v16, s[8:11], s35 offen lds
    buffer_load_dwordx4 v17, s[8:11], s35 offen offset:1024 lds
    buffer_load_dwordx4 v18, s[8:11], s35 offen offset:2048 lds
    s_add_u32 m0, s33, 76800
    s_add_u32 s35, s43, 49152
    buffer_load_dwordx4 v16, s[8:11], s35 offen lds
    buffer_load_dwordx4 v17, s[8:11], s35 offen offset:1024 lds
    buffer_load_dwordx4 v18, s[8:11], s35 offen offset:2048 lds
    s_add_u32 m0, s31, 98304
    s_add_u32 s34, s36, 0
    buffer_load_dwordx4 v20, s[4:7], s34 offen lds
    s_add_u32 m0, s31, 99328
    s_add_u32 s34, s36, 4096
    buffer_load_dwordx4 v21, s[4:7], s34 offen lds
    s_add_u32 m0, s31, 100352
    s_add_u32 s34, s36, 8192
    buffer_load_dwordx4 v22, s[4:7], s34 offen lds
    s_add_u32 m0, s31, 101376
    s_add_u32 s34, s36, 12288
    buffer_load_dwordx4 v23, s[4:7], s34 offen lds
    s_add_u32 m0, s31, 102400
    s_add_u32 s34, s36, 16384
    buffer_load_dwordx4 v20, s[4:7], s34 offen lds
    s_add_u32 m0, s31, 103424
    s_add_u32 s34, s36, 20480
    buffer_load_dwordx4 v21, s[4:7], s34 offen lds
    s_add_u32 m0, s31, 104448
    s_add_u32 s34, s36, 24576
    buffer_load_dwordx4 v22, s[4:7], s34 offen lds
    s_add_u32 m0, s31, 105472
    s_add_u32 s34, s36, 28672
    buffer_load_dwordx4 v23, s[4:7], s34 offen lds
    s_waitcnt vmcnt(14)
    s_barrier
    s_add_u32 m0, s31, 0
    s_add_u32 s34, s37, 0
    buffer_load_dwordx4 v20, s[4:7], s34 offen lds
    s_add_u32 m0, s31, 1024
    s_add_u32 s34, s37, 4096
    buffer_load_dwordx4 v21, s[4:7], s34 offen lds
    s_add_u32 m0, s31, 2048
    s_add_u32 s34, s37, 8192
    buffer_load_dwordx4 v22, s[4:7], s34 offen lds
    s_add_u32 m0, s31, 3072
    s_add_u32 s34, s37, 12288
    buffer_load_dwordx4 v23, s[4:7], s34 offen lds
    s_add_u32 m0, s31, 4096
    s_add_u32 s34, s37, 16384
    buffer_load_dwordx4 v20, s[4:7], s34 offen lds
    s_add_u32 m0, s31, 5120
    s_add_u32 s34, s37, 20480
    buffer_load_dwordx4 v21, s[4:7], s34 offen lds
    s_add_u32 m0, s31, 6144
    s_add_u32 s34, s37, 24576
    buffer_load_dwordx4 v22, s[4:7], s34 offen lds
    s_add_u32 m0, s31, 7168
    s_add_u32 s34, s37, 28672
    buffer_load_dwordx4 v23, s[4:7], s34 offen lds
    s_waitcnt vmcnt(8)
    s_barrier
    s_add_u32 m0, s33, 0
    s_add_u32 s35, s40, 0
    buffer_load_dwordx4 v16, s[8:11], s35 offen lds
    buffer_load_dwordx4 v17, s[8:11], s35 offen offset:1024 lds
    buffer_load_dwordx4 v18, s[8:11], s35 offen offset:2048 lds
    s_add_u32 m0, s33, 3072
    s_add_u32 s35, s40, 49152
    buffer_load_dwordx4 v16, s[8:11], s35 offen lds
    buffer_load_dwordx4 v17, s[8:11], s35 offen offset:1024 lds
    buffer_load_dwordx4 v18, s[8:11], s35 offen offset:2048 lds
    s_add_u32 m0, s31, 32768
    s_add_u32 s34, s38, 0
    buffer_load_dwordx4 v20, s[4:7], s34 offen lds
    s_add_u32 m0, s31, 33792
    s_add_u32 s34, s38, 4096
    buffer_load_dwordx4 v21, s[4:7], s34 offen lds
    s_add_u32 m0, s31, 34816
    s_add_u32 s34, s38, 8192
    buffer_load_dwordx4 v22, s[4:7], s34 offen lds
    s_add_u32 m0, s31, 35840
    s_add_u32 s34, s38, 12288
    buffer_load_dwordx4 v23, s[4:7], s34 offen lds
    s_add_u32 m0, s31, 36864
    s_add_u32 s34, s38, 16384
    buffer_load_dwordx4 v20, s[4:7], s34 offen lds
    s_add_u32 m0, s31, 37888
    s_add_u32 s34, s38, 20480
    buffer_load_dwordx4 v21, s[4:7], s34 offen lds
    s_add_u32 m0, s31, 38912
    s_add_u32 s34, s38, 24576
    buffer_load_dwordx4 v22, s[4:7], s34 offen lds
    s_add_u32 m0, s31, 39936
    s_add_u32 s34, s38, 28672
    buffer_load_dwordx4 v23, s[4:7], s34 offen lds
    s_waitcnt vmcnt(8)
    s_barrier
    s_add_u32 m0, s33, 24576
    s_add_u32 s35, s41, 0
    buffer_load_dwordx4 v16, s[8:11], s35 offen lds
    buffer_load_dwordx4 v17, s[8:11], s35 offen offset:1024 lds
    buffer_load_dwordx4 v18, s[8:11], s35 offen offset:2048 lds
    s_add_u32 m0, s33, 27648
    s_add_u32 s35, s41, 49152
    buffer_load_dwordx4 v16, s[8:11], s35 offen lds
    buffer_load_dwordx4 v17, s[8:11], s35 offen offset:1024 lds
    buffer_load_dwordx4 v18, s[8:11], s35 offen offset:2048 lds
    s_add_u32 m0, s33, 49152
    s_add_u32 s35, s42, 0
    buffer_load_dwordx4 v16, s[8:11], s35 offen lds
    buffer_load_dwordx4 v17, s[8:11], s35 offen offset:1024 lds
    buffer_load_dwordx4 v18, s[8:11], s35 offen offset:2048 lds
    s_add_u32 m0, s33, 52224
    s_add_u32 s35, s42, 49152
    buffer_load_dwordx4 v16, s[8:11], s35 offen lds
    buffer_load_dwordx4 v17, s[8:11], s35 offen offset:1024 lds
    buffer_load_dwordx4 v18, s[8:11], s35 offen offset:2048 lds
    s_mov_b32 s12, s82
    s_mov_b32 s13, s83
    s_mov_b32 s14, 0x10000000
    s_mov_b32 s15, 0x00020000
    s_mov_b32 s44, s68
    s_mov_b32 s45, s69
    s_mov_b32 s46, 0x80000
    s_mov_b32 s47, 0x00020000
    s_mov_b32 s48, s72
    s_mov_b32 s49, s73
    s_mov_b32 s50, 0x158000
    s_mov_b32 s51, 0x00020000
    s_mov_b32 s56, s74
    s_mov_b32 s57, s75
    s_mov_b32 s58, 0xac0
    s_mov_b32 s59, 0x00020000
    s_mov_b32 s52, s76
    s_mov_b32 s53, s77
    s_mov_b32 s54, 0x158000
    s_mov_b32 s55, 0x00020000
    s_mov_b32 s16, s78
    s_mov_b32 s17, s79
    s_mov_b32 s18, 0x200000
    s_mov_b32 s19, 0x00020000
    s_mov_b32 s8, s80
    s_mov_b32 s9, s81
    s_mov_b32 s10, 0x100
    s_mov_b32 s11, 0x00020000
    v_bfe_u32 v2, v1, 2, 2
    v_lshl_add_u32 v2, v5, 2, v2
    v_mul_u32_u24 v2, 192, v2
    v_bfe_u32 v3, v1, 4, 1
    v_lshl_add_u32 v2, v3, 5, v2
    v_and_b32 v3, 3, v1
    v_lshl_add_u32 v24, v3, 3, v2
    s_mul_i32 s30, s21, 6144
    s_add_u32 s30, s30, 65536
    v_add_u32 v24, s30, v24
    v_add_u32 v25, 49152, v24
    v_mov_b32 v28, 0x3f803f80
    v_mov_b32 v29, 0x3f803f80
    v_mov_b32 v30, 0x3f803f80
    v_mov_b32 v31, 0x3f803f80
    s_setprio 3
    ds_read_b64_tr_b16 v[32:33], v25 offset:24576
    ds_read_b64_tr_b16 v[34:35], v25 offset:26112
    ds_read_b64_tr_b16 v[36:37], v25 offset:24640
    ds_read_b64_tr_b16 v[38:39], v25 offset:26176
    ds_read_b64_tr_b16 v[40:41], v25 offset:24704
    ds_read_b64_tr_b16 v[42:43], v25 offset:26240
    ds_read_b64_tr_b16 v[44:45], v25 offset:27648
    ds_read_b64_tr_b16 v[46:47], v25 offset:29184
    ds_read_b64_tr_b16 v[48:49], v25 offset:27712
    ds_read_b64_tr_b16 v[50:51], v25 offset:29248
    ds_read_b64_tr_b16 v[52:53], v25 offset:27776
    ds_read_b64_tr_b16 v[54:55], v25 offset:29312
    s_waitcnt lgkmcnt(6)
    v_mfma_f32_32x32x16_bf16 v[64:79], v[28:31], v[32:35], 0
    v_mfma_f32_32x32x16_bf16 v[80:95], v[28:31], v[36:39], 0
    v_mfma_f32_32x32x16_bf16 v[96:111], v[28:31], v[40:43], 0
    s_waitcnt lgkmcnt(0)
    v_mfma_f32_32x32x16_bf16 v[64:79], v[28:31], v[44:47], v[64:79]
    v_mfma_f32_32x32x16_bf16 v[80:95], v[28:31], v[48:51], v[80:95]
    v_mfma_f32_32x32x16_bf16 v[96:111], v[28:31], v[52:55], v[96:111]
    ds_read_b64_tr_b16 v[32:33], v24 offset:0
    ds_read_b64_tr_b16 v[34:35], v24 offset:1536
    ds_read_b64_tr_b16 v[36:37], v24 offset:64
    ds_read_b64_tr_b16 v[38:39], v24 offset:1600
    ds_read_b64_tr_b16 v[40:41], v24 offset:128
    ds_read_b64_tr_b16 v[42:43], v24 offset:1664
    ds_read_b64_tr_b16 v[44:45], v24 offset:3072
    ds_read_b64_tr_b16 v[46:47], v24 offset:4608
    ds_read_b64_tr_b16 v[48:49], v24 offset:3136
    ds_read_b64_tr_b16 v[50:51], v24 offset:4672
    ds_read_b64_tr_b16 v[52:53], v24 offset:3200
    ds_read_b64_tr_b16 v[54:55], v24 offset:4736
    s_waitcnt lgkmcnt(6)
    v_mfma_f32_32x32x16_bf16 v[64:79], v[28:31], v[32:35], v[64:79]
    v_mfma_f32_32x32x16_bf16 v[80:95], v[28:31], v[36:39], v[80:95]
    v_mfma_f32_32x32x16_bf16 v[96:111], v[28:31], v[40:43], v[96:111]
    s_waitcnt lgkmcnt(0)
    v_mfma_f32_32x32x16_bf16 v[64:79], v[28:31], v[44:47], v[64:79]
    v_mfma_f32_32x32x16_bf16 v[80:95], v[28:31], v[48:51], v[80:95]
    v_mfma_f32_32x32x16_bf16 v[96:111], v[28:31], v[52:55], v[96:111]
    s_waitcnt vmcnt(6)
    ds_read_b64_tr_b16 v[32:33], v24 offset:24576
    ds_read_b64_tr_b16 v[34:35], v24 offset:26112
    ds_read_b64_tr_b16 v[36:37], v24 offset:24640
    ds_read_b64_tr_b16 v[38:39], v24 offset:26176
    ds_read_b64_tr_b16 v[40:41], v24 offset:24704
    ds_read_b64_tr_b16 v[42:43], v24 offset:26240
    ds_read_b64_tr_b16 v[44:45], v24 offset:27648
    ds_read_b64_tr_b16 v[46:47], v24 offset:29184
    ds_read_b64_tr_b16 v[48:49], v24 offset:27712
    ds_read_b64_tr_b16 v[50:51], v24 offset:29248
    ds_read_b64_tr_b16 v[52:53], v24 offset:27776
    ds_read_b64_tr_b16 v[54:55], v24 offset:29312
    s_waitcnt lgkmcnt(6)
    v_mfma_f32_32x32x16_bf16 v[64:79], v[28:31], v[32:35], v[64:79]
    v_mfma_f32_32x32x16_bf16 v[80:95], v[28:31], v[36:39], v[80:95]
    v_mfma_f32_32x32x16_bf16 v[96:111], v[28:31], v[40:43], v[96:111]
    s_waitcnt lgkmcnt(0)
    v_mfma_f32_32x32x16_bf16 v[64:79], v[28:31], v[44:47], v[64:79]
    v_mfma_f32_32x32x16_bf16 v[80:95], v[28:31], v[48:51], v[80:95]
    v_mfma_f32_32x32x16_bf16 v[96:111], v[28:31], v[52:55], v[96:111]
    s_barrier
    s_waitcnt vmcnt(0)
    ds_read_b64_tr_b16 v[32:33], v25 offset:0
    ds_read_b64_tr_b16 v[34:35], v25 offset:1536
    ds_read_b64_tr_b16 v[36:37], v25 offset:64
    ds_read_b64_tr_b16 v[38:39], v25 offset:1600
    ds_read_b64_tr_b16 v[40:41], v25 offset:128
    ds_read_b64_tr_b16 v[42:43], v25 offset:1664
    ds_read_b64_tr_b16 v[44:45], v25 offset:3072
    ds_read_b64_tr_b16 v[46:47], v25 offset:4608
    ds_read_b64_tr_b16 v[48:49], v25 offset:3136
    ds_read_b64_tr_b16 v[50:51], v25 offset:4672
    ds_read_b64_tr_b16 v[52:53], v25 offset:3200
    ds_read_b64_tr_b16 v[54:55], v25 offset:4736
    s_waitcnt lgkmcnt(6)
    v_mfma_f32_32x32x16_bf16 v[64:79], v[28:31], v[32:35], v[64:79]
    v_mfma_f32_32x32x16_bf16 v[80:95], v[28:31], v[36:39], v[80:95]
    v_mfma_f32_32x32x16_bf16 v[96:111], v[28:31], v[40:43], v[96:111]
    s_waitcnt lgkmcnt(0)
    v_mfma_f32_32x32x16_bf16 v[64:79], v[28:31], v[44:47], v[64:79]
    v_mfma_f32_32x32x16_bf16 v[80:95], v[28:31], v[48:51], v[80:95]
    v_mfma_f32_32x32x16_bf16 v[96:111], v[28:31], v[52:55], v[96:111]
    s_barrier
    s_nop 8
    v_cvt_pk_bf16_f32 v8, v64, v64
    v_and_b32 v2, 0xffff0000, v8
    v_sub_f32 v2, v64, v2
    v_cvt_pk_bf16_f32 v9, v2, 0
    v_cvt_pk_bf16_f32 v10, v80, v80
    v_and_b32 v2, 0xffff0000, v10
    v_sub_f32 v2, v80, v2
    v_cvt_pk_bf16_f32 v11, v2, 0
    v_cvt_pk_bf16_f32 v12, v96, v96
    v_and_b32 v2, 0xffff0000, v12
    v_sub_f32 v2, v96, v2
    v_cvt_pk_bf16_f32 v13, v2, 0
    v_and_b32 v2, 31, v1
    s_lshr_b32 s30, s21, 1
    s_lshl_b32 s30, s30, 9
    s_and_b32 s31, s21, 1
    s_lshl_b32 s31, s31, 3
    s_add_u32 s30, s30, s31
    s_add_u32 s30, s30, 61440
    v_lshl_add_u32 v2, v2, 4, s30
    ds_write_b64 v2, v[8:9] offset:0
    ds_write_b64 v2, v[10:11] offset:1024
    ds_write_b64 v2, v[12:13] offset:2048
    s_setprio 0
    s_mul_i32 s30, s21, 24576
    s_add_u32 s30, s30, 65536
    v_add_u32 v20, s30, v4
    s_min_u32 s30, s21, 2
    s_lshl_b32 s30, s30, 10
    v_add_u32 v21, s30, v4
    s_waitcnt lgkmcnt(0)
    s_barrier
    s_mov_b32 s28, 0x10000
    v_mov_b32 v7, 0
    s_nop 4
Lzp_3:
    buffer_load_dwordx2 v[2:3], v7, s[8:11], 0 offen sc1
    s_sub_u32 s28, s28, 1
    s_cbranch_scc1 Lz_2
    s_waitcnt vmcnt(0)
    v_cmp_eq_u32 vcc, 0, v2
    s_nop 4
    s_cbranch_vccnz Lzp_3
Lz_2:
    s_waitcnt vmcnt(0)
    v_readfirstlane_b32 s8, v2
    v_readfirstlane_b32 s9, v3
    s_barrier
    ds_read_b128 v[156:159], v20 offset:0
    ds_read_b128 v[160:163], v20 offset:1024
    ds_read_b128 v[164:167], v20 offset:2048
    ds_read_b128 v[168:171], v20 offset:3072
    ds_read_b128 v[172:175], v20 offset:4096
    ds_read_b128 v[176:179], v20 offset:5120
    ds_read_b128 v[180:183], v20 offset:6144
    ds_read_b128 v[184:187], v20 offset:7168
    ds_read_b128 v[188:191], v20 offset:8192
    ds_read_b128 v[192:195], v20 offset:9216
    ds_read_b128 v[196:199], v20 offset:10240
    ds_read_b128 v[200:203], v20 offset:11264
    ds_read_b128 v[204:207], v20 offset:12288
    ds_read_b128 v[208:211], v20 offset:13312
    ds_read_b128 v[212:215], v20 offset:14336
    ds_read_b128 v[216:219], v20 offset:15360
    ds_read_b128 v[220:223], v20 offset:16384
    ds_read_b128 v[224:227], v20 offset:17408
    ds_read_b128 v[228:231], v20 offset:18432
    ds_read_b128 v[232:235], v20 offset:19456
    ds_read_b128 v[236:239], v20 offset:20480
    ds_read_b128 v[240:243], v20 offset:21504
    ds_read_b128 v[244:247], v20 offset:22528
    ds_read_b128 v[248:251], v20 offset:23552
    ds_read_b128 v[252:255], v21 offset:61440
    s_lshl_b32 s30, s93, 9
    s_and_b32 s31, s92, 0x3c
    s_lshl_b32 s31, s31, 1
    s_add_u32 s30, s30, s31
    s_add_u32 s30, s30, 0x1300000
    s_cmp_eq_u32 s20, 4
    s_cselect_b32 s30, s30, s98
    v_add_u32 v20, 162816, v6
    v_mov_b32 v18, 0
    v_mov_b32 v21, 162816
    s_waitcnt lgkmcnt(0)
    s_barrier
    v_mov_b32 v2, s8
    v_mov_b32 v3, s9
    v_mov_b32 v7, 0
    s_mov_b64 exec, 1
    buffer_store_dwordx2 v[2:3], v7, s[12:15], s30 offen sc1
    s_mov_b64 exec, -1
    ds_write_b32 v20, v18
    ds_write_b64 v21, v[2:3] offset:256
    s_getreg_b32 s30, hwreg(HW_REG_XCC_ID, 0, 4)
    s_lshl_b32 s30, s30, 28
    s_xor_b32 s30, s30, s9
    s_lshl_b32 s31, s23, 9
    s_lshl_b32 s32, s24, 3
    s_add_u32 s31, s31, s32
    s_add_u32 s31, s31, 0x130e000
    s_cmp_eq_u32 s20, 5
    s_cselect_b32 s31, s31, s98
    v_mov_b32 v22, s8
    v_mov_b32 v23, s30
    s_mov_b64 exec, 1
    buffer_store_dwordx2 v[22:23], v7, s[12:15], s31 offen sc1
    s_mov_b64 exec, -1
    s_waitcnt lgkmcnt(0)
    s_barrier
    s_branch mega_layer
Lp0comp_1:
    v_lshlrev_b32 v2, 7, v1
    s_lshl_b32 s30, s24, 2
    s_add_u32 s30, s30, s21
    s_lshl_b32 s30, s30, 11
    s_lshl_b32 s33, s23, 18
    s_add_u32 s33, s33, s30
    s_lshl_b32 s30, s2, 2
    s_add_u32 s30, s30, s21
    s_mul_i32 s32, s30, 1536
    s_waitcnt lgkmcnt(0)
    s_mov_b32 s4, s64
    s_mov_b32 s5, s65
    s_mov_b32 s6, 0x200000
    s_mov_b32 s7, 0x00020000
    s_mov_b64 exec, 0xffff
    buffer_load_dword v11, v2, s[4:7], s33 offen
    s_mov_b32 s8, s66
    s_mov_b32 s9, s67
    s_mov_b32 s10, 0x180000
    s_mov_b32 s11, 0x00020000
    s_mov_b64 exec, 0xfff
    buffer_load_dword v10, v2, s[8:11], s32 offen
    s_mov_b64 exec, -1
    s_setprio 2
    v_and_b32 v2, 31, v1
    v_and_b32 v3, 15, v1
    v_xor_b32 v3, v3, v5
    v_lshlrev_b32 v3, 4, v3
    v_lshl_add_u32 v2, v2, 8, v3
    s_lshl_b32 s30, s21, 13
    v_add_u32 v112, s30, v2
    v_xor_b32 v113, 32, v112
    v_xor_b32 v114, 64, v112
    v_xor_b32 v115, 96, v112
    v_xor_b32 v116, 128, v112
    v_xor_b32 v117, 160, v112
    v_xor_b32 v118, 192, v112
    v_xor_b32 v119, 224, v112
    v_bfe_u32 v2, v1, 2, 2
    v_lshl_add_u32 v2, v5, 3, v2
    v_mul_u32_u24 v2, 192, v2
    v_bfe_u32 v3, v1, 4, 1
    v_lshl_add_u32 v2, v3, 5, v2
    v_and_b32 v3, 3, v1
    v_lshl_add_u32 v16, v3, 3, v2
    v_add_u32 v16, 65536, v16
    v_add_u32 v17, 49152, v16
    s_mul_i32 s30, s21, 2304
    s_add_u32 s30, s30, 40960
    v_bfe_u32 v2, v1, 2, 2
    v_lshl_add_u32 v2, v5, 2, v2
    v_mul_u32_u24 v2, 72, v2
    v_bfe_u32 v3, v1, 4, 1
    v_lshl_add_u32 v2, v3, 5, v2
    v_and_b32 v3, 3, v1
    v_lshl_add_u32 v19, v3, 3, v2
    v_add_u32 v19, s30, v19
    v_and_b32 v2, 31, v1
    v_mul_u32_u24 v2, 72, v2
    v_lshl_add_u32 v2, v5, 3, v2
    v_add_u32 v18, s30, v2
    v_bfe_u32 v2, v1, 4, 1
    v_lshlrev_b32 v2, 16, v2
    v_lshl_add_u32 v2, v5, 8, v2
    v_and_b32 v3, 15, v1
    v_lshl_add_u32 v20, v3, 4, v2
    v_mov_b32 v120, 0
    v_mov_b32 v121, 0
    v_mov_b32 v122, 0
    v_mov_b32 v123, 0
    s_waitcnt lgkmcnt(0)
    s_mov_b32 s4, s64
    s_mov_b32 s5, s65
    s_mov_b32 s6, 0x200000
    s_mov_b32 s7, 0x00020000
    s_mov_b32 s12, s82
    s_mov_b32 s13, s83
    s_mov_b32 s14, 0x10000000
    s_mov_b32 s15, 0x00020000
    s_mov_b32 s44, s68
    s_mov_b32 s45, s69
    s_mov_b32 s46, 0x80000
    s_mov_b32 s47, 0x00020000
    s_mov_b32 s48, s72
    s_mov_b32 s49, s73
    s_mov_b32 s50, 0x158000
    s_mov_b32 s51, 0x00020000
    s_mov_b32 s56, s74
    s_mov_b32 s57, s75
    s_mov_b32 s58, 0xac0
    s_mov_b32 s59, 0x00020000
    s_mov_b32 s52, s76
    s_mov_b32 s53, s77
    s_mov_b32 s54, 0x158000
    s_mov_b32 s55, 0x00020000
    s_mov_b32 s16, s78
    s_mov_b32 s17, s79
    s_mov_b32 s18, 0x200000
    s_mov_b32 s19, 0x00020000
    s_mov_b32 s8, s80
    s_mov_b32 s9, s81
    s_mov_b32 s10, 0x100
    s_mov_b32 s11, 0x00020000
    s_or_b32 s30, s2, s20
    s_cbranch_scc1 Lnox_4
    s_memrealtime s[30:31]
    v_mov_b32 v7, 0
    s_waitcnt lgkmcnt(0)
    s_lshl_b64 s[30:31], s[30:31], 1
    s_or_b32 s30, s30, 1
    v_mov_b32 v2, s30
    v_mov_b32 v3, s31
    s_mov_b64 exec, 1
    buffer_store_dwordx2 v[2:3], v7, s[8:11], 0 offen sc1
    s_mov_b64 exec, -1
    s_nop 1
Lnox_4:
    s_mov_b32 s35, 0x3f803f80
    v_add_u32 v112, 65536, v112
    v_add_u32 v113, 65536, v113
    v_add_u32 v114, 65536, v114
    v_add_u32 v115, 65536, v115
    v_add_u32 v116, 65536, v116
    v_add_u32 v117, 65536, v117
    v_add_u32 v118, 65536, v118
    v_add_u32 v119, 65536, v119
    s_barrier
    ds_read_b128 v[224:227], v112 offset:0
    ds_read_b128 v[228:231], v113 offset:0
    ds_read_b128 v[232:235], v114 offset:0
    ds_read_b128 v[236:239], v115 offset:0
    ds_read_b128 v[240:243], v116 offset:0
    ds_read_b128 v[244:247], v117 offset:0
    ds_read_b128 v[248:251], v118 offset:0
    ds_read_b128 v[252:255], v119 offset:0
    s_waitcnt lgkmcnt(0)
    v_dot2c_f32_bf16 v120, s35, v224
    v_dot2c_f32_bf16 v122, v224, v224
    v_dot2c_f32_bf16 v121, s35, v225
    v_dot2c_f32_bf16 v123, v225, v225
    v_dot2c_f32_bf16 v120, s35, v226
    v_dot2c_f32_bf16 v122, v226, v226
    v_dot2c_f32_bf16 v121, s35, v227
    v_dot2c_f32_bf16 v123, v227, v227
    v_dot2c_f32_bf16 v120, s35, v228
    v_dot2c_f32_bf16 v122, v228, v228
    v_dot2c_f32_bf16 v121, s35, v229
    v_dot2c_f32_bf16 v123, v229, v229
    v_dot2c_f32_bf16 v120, s35, v230
    v_dot2c_f32_bf16 v122, v230, v230
    v_dot2c_f32_bf16 v121, s35, v231
    v_dot2c_f32_bf16 v123, v231, v231
    v_dot2c_f32_bf16 v120, s35, v232
    v_dot2c_f32_bf16 v122, v232, v232
    v_dot2c_f32_bf16 v121, s35, v233
    v_dot2c_f32_bf16 v123, v233, v233
    v_dot2c_f32_bf16 v120, s35, v234
    v_dot2c_f32_bf16 v122, v234, v234
    v_dot2c_f32_bf16 v121, s35, v235
    v_dot2c_f32_bf16 v123, v235, v235
    v_dot2c_f32_bf16 v120, s35, v236
    v_dot2c_f32_bf16 v122, v236, v236
    v_dot2c_f32_bf16 v121, s35, v237
    v_dot2c_f32_bf16 v123, v237, v237
    v_dot2c_f32_bf16 v120, s35, v238
    v_dot2c_f32_bf16 v122, v238, v238
    v_dot2c_f32_bf16 v121, s35, v239
    v_dot2c_f32_bf16 v123, v239, v239
    v_dot2c_f32_bf16 v120, s35, v240
    v_dot2c_f32_bf16 v122, v240, v240
    v_dot2c_f32_bf16 v121, s35, v241
    v_dot2c_f32_bf16 v123, v241, v241
    v_dot2c_f32_bf16 v120, s35, v242
    v_dot2c_f32_bf16 v122, v242, v242
    v_dot2c_f32_bf16 v121, s35, v243
    v_dot2c_f32_bf16 v123, v243, v243
    v_dot2c_f32_bf16 v120, s35, v244
    v_dot2c_f32_bf16 v122, v244, v244
    v_dot2c_f32_bf16 v121, s35, v245
    v_dot2c_f32_bf16 v123, v245, v245
    v_dot2c_f32_bf16 v120, s35, v246
    v_dot2c_f32_bf16 v122, v246, v246
    v_dot2c_f32_bf16 v121, s35, v247
    v_dot2c_f32_bf16 v123, v247, v247
    v_dot2c_f32_bf16 v120, s35, v248
    v_dot2c_f32_bf16 v122, v248, v248
    v_dot2c_f32_bf16 v121, s35, v249
    v_dot2c_f32_bf16 v123, v249, v249
    v_dot2c_f32_bf16 v120, s35, v250
    v_dot2c_f32_bf16 v122, v250, v250
    v_dot2c_f32_bf16 v121, s35, v251
    v_dot2c_f32_bf16 v123, v251, v251
    v_dot2c_f32_bf16 v120, s35, v252
    v_dot2c_f32_bf16 v122, v252, v252
    v_dot2c_f32_bf16 v121, s35, v253
    v_dot2c_f32_bf16 v123, v253, v253
    v_dot2c_f32_bf16 v120, s35, v254
    v_dot2c_f32_bf16 v122, v254, v254
    v_dot2c_f32_bf16 v121, s35, v255
    v_dot2c_f32_bf16 v123, v255, v255
    s_barrier
    ds_read_b128 v[128:131], v112 offset:32768
    ds_read_b128 v[132:135], v113 offset:32768
    ds_read_b128 v[136:139], v114 offset:32768
    ds_read_b128 v[140:143], v115 offset:32768
    ds_read_b128 v[144:147], v116 offset:32768
    ds_read_b128 v[148:151], v117 offset:32768
    ds_read_b128 v[152:155], v118 offset:32768
    ds_read_b128 v[156:159], v119 offset:32768
    ds_read_b64_tr_b16 v[28:29], v17 offset:24576
    ds_read_b64_tr_b16 v[30:31], v17 offset:25344
    ds_read_b64_tr_b16 v[32:33], v17 offset:24640
    ds_read_b64_tr_b16 v[34:35], v17 offset:25408
    ds_read_b64_tr_b16 v[36:37], v17 offset:24704
    ds_read_b64_tr_b16 v[38:39], v17 offset:25472
    ds_read_b64_tr_b16 v[40:41], v17 offset:30720
    ds_read_b64_tr_b16 v[42:43], v17 offset:31488
    ds_read_b64_tr_b16 v[44:45], v17 offset:30784
    ds_read_b64_tr_b16 v[46:47], v17 offset:31552
    ds_read_b64_tr_b16 v[48:49], v17 offset:30848
    ds_read_b64_tr_b16 v[50:51], v17 offset:31616
    s_waitcnt lgkmcnt(12)
    v_dot2c_f32_bf16 v120, s35, v128
    v_dot2c_f32_bf16 v122, v128, v128
    v_dot2c_f32_bf16 v121, s35, v129
    v_dot2c_f32_bf16 v123, v129, v129
    v_dot2c_f32_bf16 v120, s35, v130
    v_dot2c_f32_bf16 v122, v130, v130
    v_dot2c_f32_bf16 v121, s35, v131
    v_dot2c_f32_bf16 v123, v131, v131
    v_dot2c_f32_bf16 v120, s35, v132
    v_dot2c_f32_bf16 v122, v132, v132
    v_dot2c_f32_bf16 v121, s35, v133
    v_dot2c_f32_bf16 v123, v133, v133
    v_dot2c_f32_bf16 v120, s35, v134
    v_dot2c_f32_bf16 v122, v134, v134
    v_dot2c_f32_bf16 v121, s35, v135
    v_dot2c_f32_bf16 v123, v135, v135
    v_dot2c_f32_bf16 v120, s35, v136
    v_dot2c_f32_bf16 v122, v136, v136
    v_dot2c_f32_bf16 v121, s35, v137
    v_dot2c_f32_bf16 v123, v137, v137
    v_dot2c_f32_bf16 v120, s35, v138
    v_dot2c_f32_bf16 v122, v138, v138
    v_dot2c_f32_bf16 v121, s35, v139
    v_dot2c_f32_bf16 v123, v139, v139
    v_dot2c_f32_bf16 v120, s35, v140
    v_dot2c_f32_bf16 v122, v140, v140
    v_dot2c_f32_bf16 v121, s35, v141
    v_dot2c_f32_bf16 v123, v141, v141
    v_dot2c_f32_bf16 v120, s35, v142
    v_dot2c_f32_bf16 v122, v142, v142
    v_dot2c_f32_bf16 v121, s35, v143
    v_dot2c_f32_bf16 v123, v143, v143
    v_dot2c_f32_bf16 v120, s35, v144
    v_dot2c_f32_bf16 v122, v144, v144
    v_dot2c_f32_bf16 v121, s35, v145
    v_dot2c_f32_bf16 v123, v145, v145
    v_dot2c_f32_bf16 v120, s35, v146
    v_dot2c_f32_bf16 v122, v146, v146
    v_dot2c_f32_bf16 v121, s35, v147
    v_dot2c_f32_bf16 v123, v147, v147
    v_dot2c_f32_bf16 v120, s35, v148
    v_dot2c_f32_bf16 v122, v148, v148
    v_dot2c_f32_bf16 v121, s35, v149
    v_dot2c_f32_bf16 v123, v149, v149
    v_dot2c_f32_bf16 v120, s35, v150
    v_dot2c_f32_bf16 v122, v150, v150
    v_dot2c_f32_bf16 v121, s35, v151
    v_dot2c_f32_bf16 v123, v151, v151
    v_dot2c_f32_bf16 v120, s35, v152
    v_dot2c_f32_bf16 v122, v152, v152
    v_dot2c_f32_bf16 v121, s35, v153
    v_dot2c_f32_bf16 v123, v153, v153
    v_dot2c_f32_bf16 v120, s35, v154
    v_dot2c_f32_bf16 v122, v154, v154
    v_dot2c_f32_bf16 v121, s35, v155
    v_dot2c_f32_bf16 v123, v155, v155
    v_dot2c_f32_bf16 v120, s35, v156
    v_dot2c_f32_bf16 v122, v156, v156
    v_dot2c_f32_bf16 v121, s35, v157
    v_dot2c_f32_bf16 v123, v157, v157
    v_dot2c_f32_bf16 v120, s35, v158
    v_dot2c_f32_bf16 v122, v158, v158
    v_dot2c_f32_bf16 v121, s35, v159
    v_dot2c_f32_bf16 v123, v159, v159
    s_waitcnt lgkmcnt(6)
    v_mfma_f32_32x32x16_bf16 v[64:79], v[28:31], v[224:227], 0
    ds_read_b64_tr_b16 v[52:53], v17 offset:36864
    ds_read_b64_tr_b16 v[54:55], v17 offset:37632
    v_subrev_u32 v112, 65536, v112
    v_subrev_u32 v113, 65536, v113
    v_mfma_f32_32x32x16_bf16 v[80:95], v[32:35], v[224:227], 0
    ds_read_b64_tr_b16 v[56:57], v17 offset:36928
    ds_read_b64_tr_b16 v[58:59], v17 offset:37696
    v_subrev_u32 v114, 65536, v114
    v_subrev_u32 v115, 65536, v115
    v_mfma_f32_32x32x16_bf16 v[96:111], v[36:39], v[224:227], 0
    ds_read_b64_tr_b16 v[60:61], v17 offset:36992
    ds_read_b64_tr_b16 v[62:63], v17 offset:37760
    v_subrev_u32 v116, 65536, v116
    v_subrev_u32 v117, 65536, v117
    s_waitcnt lgkmcnt(6)
    v_mfma_f32_32x32x16_bf16 v[64:79], v[40:43], v[232:235], v[64:79]
    ds_read_b64_tr_b16 v[28:29], v17 offset:43008
    ds_read_b64_tr_b16 v[30:31], v17 offset:43776
    v_subrev_u32 v118, 65536, v118
    v_subrev_u32 v119, 65536, v119
    v_mfma_f32_32x32x16_bf16 v[80:95], v[44:47], v[232:235], v[80:95]
    ds_read_b64_tr_b16 v[32:33], v17 offset:43072
    ds_read_b64_tr_b16 v[34:35], v17 offset:43840
    v_mfma_f32_32x32x16_bf16 v[96:111], v[48:51], v[232:235], v[96:111]
    ds_read_b64_tr_b16 v[36:37], v17 offset:43136
    ds_read_b64_tr_b16 v[38:39], v17 offset:43904
    s_waitcnt lgkmcnt(6)
    v_mfma_f32_32x32x16_bf16 v[64:79], v[52:55], v[240:243], v[64:79]
    ds_read_b64_tr_b16 v[40:41], v17 offset:27648
    ds_read_b64_tr_b16 v[42:43], v17 offset:28416
    v_mfma_f32_32x32x16_bf16 v[80:95], v[56:59], v[240:243], v[80:95]
    ds_read_b64_tr_b16 v[44:45], v17 offset:27712
    ds_read_b64_tr_b16 v[46:47], v17 offset:28480
    v_mfma_f32_32x32x16_bf16 v[96:111], v[60:63], v[240:243], v[96:111]
    ds_read_b64_tr_b16 v[48:49], v17 offset:27776
    ds_read_b64_tr_b16 v[50:51], v17 offset:28544
    s_waitcnt lgkmcnt(6)
    v_mfma_f32_32x32x16_bf16 v[64:79], v[28:31], v[248:251], v[64:79]
    ds_read_b64_tr_b16 v[52:53], v17 offset:33792
    ds_read_b64_tr_b16 v[54:55], v17 offset:34560
    v_mfma_f32_32x32x16_bf16 v[80:95], v[32:35], v[248:251], v[80:95]
    ds_read_b64_tr_b16 v[56:57], v17 offset:33856
    ds_read_b64_tr_b16 v[58:59], v17 offset:34624
    v_mfma_f32_32x32x16_bf16 v[96:111], v[36:39], v[248:251], v[96:111]
    ds_read_b64_tr_b16 v[60:61], v17 offset:33920
    ds_read_b64_tr_b16 v[62:63], v17 offset:34688
    s_waitcnt lgkmcnt(6)
    v_mfma_f32_32x32x16_bf16 v[64:79], v[40:43], v[228:231], v[64:79]
    ds_read_b64_tr_b16 v[28:29], v17 offset:39936
    ds_read_b64_tr_b16 v[30:31], v17 offset:40704
    v_mfma_f32_32x32x16_bf16 v[80:95], v[44:47], v[228:231], v[80:95]
    ds_read_b64_tr_b16 v[32:33], v17 offset:40000
    ds_read_b64_tr_b16 v[34:35], v17 offset:40768
    v_mfma_f32_32x32x16_bf16 v[96:111], v[48:51], v[228:231], v[96:111]
    ds_read_b64_tr_b16 v[36:37], v17 offset:40064
    ds_read_b64_tr_b16 v[38:39], v17 offset:40832
    s_waitcnt lgkmcnt(6)
    v_mfma_f32_32x32x16_bf16 v[64:79], v[52:55], v[236:239], v[64:79]
    ds_read_b64_tr_b16 v[40:41], v17 offset:46080
    ds_read_b64_tr_b16 v[42:43], v17 offset:46848
    v_mfma_f32_32x32x16_bf16 v[80:95], v[56:59], v[236:239], v[80:95]
    ds_read_b64_tr_b16 v[44:45], v17 offset:46144
    ds_read_b64_tr_b16 v[46:47], v17 offset:46912
    v_mfma_f32_32x32x16_bf16 v[96:111], v[60:63], v[236:239], v[96:111]
    ds_read_b64_tr_b16 v[48:49], v17 offset:46208
    ds_read_b64_tr_b16 v[50:51], v17 offset:46976
    s_waitcnt lgkmcnt(6)
    v_mfma_f32_32x32x16_bf16 v[64:79], v[28:31], v[244:247], v[64:79]
    v_mfma_f32_32x32x16_bf16 v[80:95], v[32:35], v[244:247], v[80:95]
    v_mfma_f32_32x32x16_bf16 v[96:111], v[36:39], v[244:247], v[96:111]
    s_waitcnt lgkmcnt(0)
    v_mfma_f32_32x32x16_bf16 v[64:79], v[40:43], v[252:255], v[64:79]
    v_mfma_f32_32x32x16_bf16 v[80:95], v[44:47], v[252:255], v[80:95]
    v_mfma_f32_32x32x16_bf16 v[96:111], v[48:51], v[252:255], v[96:111]
    s_barrier
    ds_read_b128 v[160:163], v112 offset:0
    ds_read_b128 v[164:167], v113 offset:0
    ds_read_b128 v[168:171], v114 offset:0
    ds_read_b128 v[172:175], v115 offset:0
    ds_read_b128 v[176:179], v116 offset:0
    ds_read_b128 v[180:183], v117 offset:0
    ds_read_b128 v[184:187], v118 offset:0
    ds_read_b128 v[188:191], v119 offset:0
    ds_read_b64_tr_b16 v[52:53], v16 offset:0
    ds_read_b64_tr_b16 v[54:55], v16 offset:768
    ds_read_b64_tr_b16 v[56:57], v16 offset:64
    ds_read_b64_tr_b16 v[58:59], v16 offset:832
    ds_read_b64_tr_b16 v[60:61], v16 offset:128
    ds_read_b64_tr_b16 v[62:63], v16 offset:896
    ds_read_b64_tr_b16 v[28:29], v16 offset:6144
    ds_read_b64_tr_b16 v[30:31], v16 offset:6912
    ds_read_b64_tr_b16 v[32:33], v16 offset:6208
    ds_read_b64_tr_b16 v[34:35], v16 offset:6976
    ds_read_b64_tr_b16 v[36:37], v16 offset:6272
    ds_read_b64_tr_b16 v[38:39], v16 offset:7040
    s_waitcnt lgkmcnt(6)
    v_mfma_f32_32x32x16_bf16 v[64:79], v[52:55], v[128:131], v[64:79]
    ds_read_b64_tr_b16 v[40:41], v16 offset:12288
    ds_read_b64_tr_b16 v[42:43], v16 offset:13056
    v_mfma_f32_32x32x16_bf16 v[80:95], v[56:59], v[128:131], v[80:95]
    ds_read_b64_tr_b16 v[44:45], v16 offset:12352
    ds_read_b64_tr_b16 v[46:47], v16 offset:13120
    v_mfma_f32_32x32x16_bf16 v[96:111], v[60:63], v[128:131], v[96:111]
    ds_read_b64_tr_b16 v[48:49], v16 offset:12416
    ds_read_b64_tr_b16 v[50:51], v16 offset:13184
    s_waitcnt lgkmcnt(6)
    v_mfma_f32_32x32x16_bf16 v[64:79], v[28:31], v[136:139], v[64:79]
    ds_read_b64_tr_b16 v[52:53], v16 offset:18432
    ds_read_b64_tr_b16 v[54:55], v16 offset:19200
    v_mfma_f32_32x32x16_bf16 v[80:95], v[32:35], v[136:139], v[80:95]
    ds_read_b64_tr_b16 v[56:57], v16 offset:18496
    ds_read_b64_tr_b16 v[58:59], v16 offset:19264
    v_mfma_f32_32x32x16_bf16 v[96:111], v[36:39], v[136:139], v[96:111]
    ds_read_b64_tr_b16 v[60:61], v16 offset:18560
    ds_read_b64_tr_b16 v[62:63], v16 offset:19328
    s_waitcnt lgkmcnt(6)
    v_mfma_f32_32x32x16_bf16 v[64:79], v[40:43], v[144:147], v[64:79]
    ds_read_b64_tr_b16 v[28:29], v16 offset:3072
    ds_read_b64_tr_b16 v[30:31], v16 offset:3840
    v_mfma_f32_32x32x16_bf16 v[80:95], v[44:47], v[144:147], v[80:95]
    ds_read_b64_tr_b16 v[32:33], v16 offset:3136
    ds_read_b64_tr_b16 v[34:35], v16 offset:3904
    v_mfma_f32_32x32x16_bf16 v[96:111], v[48:51], v[144:147], v[96:111]
    ds_read_b64_tr_b16 v[36:37], v16 offset:3200
    ds_read_b64_tr_b16 v[38:39], v16 offset:3968
    s_waitcnt lgkmcnt(6)
    v_mfma_f32_32x32x16_bf16 v[64:79], v[52:55], v[152:155], v[64:79]
    ds_read_b64_tr_b16 v[40:41], v16 offset:9216
    ds_read_b64_tr_b16 v[42:43], v16 offset:9984
    v_mfma_f32_32x32x16_bf16 v[80:95], v[56:59], v[152:155], v[80:95]
    ds_read_b64_tr_b16 v[44:45], v16 offset:9280
    ds_read_b64_tr_b16 v[46:47], v16 offset:10048
    v_mfma_f32_32x32x16_bf16 v[96:111], v[60:63], v[152:155], v[96:111]
    ds_read_b64_tr_b16 v[48:49], v16 offset:9344
    ds_read_b64_tr_b16 v[50:51], v16 offset:10112
    s_waitcnt lgkmcnt(6)
    v_mfma_f32_32x32x16_bf16 v[64:79], v[28:31], v[132:135], v[64:79]
    ds_read_b64_tr_b16 v[52:53], v16 offset:15360
    ds_read_b64_tr_b16 v[54:55], v16 offset:16128
    v_mfma_f32_32x32x16_bf16 v[80:95], v[32:35], v[132:135], v[80:95]
    ds_read_b64_tr_b16 v[56:57], v16 offset:15424
    ds_read_b64_tr_b16 v[58:59], v16 offset:16192
    v_mfma_f32_32x32x16_bf16 v[96:111], v[36:39], v[132:135], v[96:111]
    ds_read_b64_tr_b16 v[60:61], v16 offset:15488
    ds_read_b64_tr_b16 v[62:63], v16 offset:16256
    s_waitcnt lgkmcnt(6)
    v_mfma_f32_32x32x16_bf16 v[64:79], v[40:43], v[140:143], v[64:79]
    ds_read_b64_tr_b16 v[28:29], v16 offset:21504
    ds_read_b64_tr_b16 v[30:31], v16 offset:22272
    v_mfma_f32_32x32x16_bf16 v[80:95], v[44:47], v[140:143], v[80:95]
    ds_read_b64_tr_b16 v[32:33], v16 offset:21568
    ds_read_b64_tr_b16 v[34:35], v16 offset:22336
    v_mfma_f32_32x32x16_bf16 v[96:111], v[48:51], v[140:143], v[96:111]
    ds_read_b64_tr_b16 v[36:37], v16 offset:21632
    ds_read_b64_tr_b16 v[38:39], v16 offset:22400
    s_waitcnt lgkmcnt(6)
    v_mfma_f32_32x32x16_bf16 v[64:79], v[52:55], v[148:151], v[64:79]
    v_mfma_f32_32x32x16_bf16 v[80:95], v[56:59], v[148:151], v[80:95]
    v_mfma_f32_32x32x16_bf16 v[96:111], v[60:63], v[148:151], v[96:111]
    s_waitcnt lgkmcnt(0)
    v_mfma_f32_32x32x16_bf16 v[64:79], v[28:31], v[156:159], v[64:79]
    v_mfma_f32_32x32x16_bf16 v[80:95], v[32:35], v[156:159], v[80:95]
    v_mfma_f32_32x32x16_bf16 v[96:111], v[36:39], v[156:159], v[96:111]
    v_dot2c_f32_bf16 v120, s35, v160
    v_dot2c_f32_bf16 v122, v160, v160
    v_dot2c_f32_bf16 v121, s35, v161
    v_dot2c_f32_bf16 v123, v161, v161
    v_dot2c_f32_bf16 v120, s35, v162
    v_dot2c_f32_bf16 v122, v162, v162
    v_dot2c_f32_bf16 v121, s35, v163
    v_dot2c_f32_bf16 v123, v163, v163
    v_dot2c_f32_bf16 v120, s35, v164
    v_dot2c_f32_bf16 v122, v164, v164
    v_dot2c_f32_bf16 v121, s35, v165
    v_dot2c_f32_bf16 v123, v165, v165
    v_dot2c_f32_bf16 v120, s35, v166
    v_dot2c_f32_bf16 v122, v166, v166
    v_dot2c_f32_bf16 v121, s35, v167
    v_dot2c_f32_bf16 v123, v167, v167
    v_dot2c_f32_bf16 v120, s35, v168
    v_dot2c_f32_bf16 v122, v168, v168
    v_dot2c_f32_bf16 v121, s35, v169
    v_dot2c_f32_bf16 v123, v169, v169
    v_dot2c_f32_bf16 v120, s35, v170
    v_dot2c_f32_bf16 v122, v170, v170
    v_dot2c_f32_bf16 v121, s35, v171
    v_dot2c_f32_bf16 v123, v171, v171
    v_dot2c_f32_bf16 v120, s35, v172
    v_dot2c_f32_bf16 v122, v172, v172
    v_dot2c_f32_bf16 v121, s35, v173
    v_dot2c_f32_bf16 v123, v173, v173
    v_dot2c_f32_bf16 v120, s35, v174
    v_dot2c_f32_bf16 v122, v174, v174
    v_dot2c_f32_bf16 v121, s35, v175
    v_dot2c_f32_bf16 v123, v175, v175
    v_dot2c_f32_bf16 v120, s35, v176
    v_dot2c_f32_bf16 v122, v176, v176
    v_dot2c_f32_bf16 v121, s35, v177
    v_dot2c_f32_bf16 v123, v177, v177
    v_dot2c_f32_bf16 v120, s35, v178
    v_dot2c_f32_bf16 v122, v178, v178
    v_dot2c_f32_bf16 v121, s35, v179
    v_dot2c_f32_bf16 v123, v179, v179
    v_dot2c_f32_bf16 v120, s35, v180
    v_dot2c_f32_bf16 v122, v180, v180
    v_dot2c_f32_bf16 v121, s35, v181
    v_dot2c_f32_bf16 v123, v181, v181
    v_dot2c_f32_bf16 v120, s35, v182
    v_dot2c_f32_bf16 v122, v182, v182
    v_dot2c_f32_bf16 v121, s35, v183
    v_dot2c_f32_bf16 v123, v183, v183
    v_dot2c_f32_bf16 v120, s35, v184
    v_dot2c_f32_bf16 v122, v184, v184
    v_dot2c_f32_bf16 v121, s35, v185
    v_dot2c_f32_bf16 v123, v185, v185
    v_dot2c_f32_bf16 v120, s35, v186
    v_dot2c_f32_bf16 v122, v186, v186
    v_dot2c_f32_bf16 v121, s35, v187
    v_dot2c_f32_bf16 v123, v187, v187
    v_dot2c_f32_bf16 v120, s35, v188
    v_dot2c_f32_bf16 v122, v188, v188
    v_dot2c_f32_bf16 v121, s35, v189
    v_dot2c_f32_bf16 v123, v189, v189
    v_dot2c_f32_bf16 v120, s35, v190
    v_dot2c_f32_bf16 v122, v190, v190
    v_dot2c_f32_bf16 v121, s35, v191
    v_dot2c_f32_bf16 v123, v191, v191
    s_barrier
    ds_read_b128 v[192:195], v112 offset:32768
    ds_read_b128 v[196:199], v113 offset:32768
    ds_read_b128 v[200:203], v114 offset:32768
    ds_read_b128 v[204:207], v115 offset:32768
    ds_read_b128 v[208:211], v116 offset:32768
    ds_read_b128 v[212:215], v117 offset:32768
    ds_read_b128 v[216:219], v118 offset:32768
    ds_read_b128 v[220:223], v119 offset:32768
    ds_read_b64_tr_b16 v[40:41], v16 offset:24576
    ds_read_b64_tr_b16 v[42:43], v16 offset:25344
    ds_read_b64_tr_b16 v[44:45], v16 offset:24640
    ds_read_b64_tr_b16 v[46:47], v16 offset:25408
    ds_read_b64_tr_b16 v[48:49], v16 offset:24704
    ds_read_b64_tr_b16 v[50:51], v16 offset:25472
    ds_read_b64_tr_b16 v[52:53], v16 offset:30720
    ds_read_b64_tr_b16 v[54:55], v16 offset:31488
    ds_read_b64_tr_b16 v[56:57], v16 offset:30784
    ds_read_b64_tr_b16 v[58:59], v16 offset:31552
    ds_read_b64_tr_b16 v[60:61], v16 offset:30848
    ds_read_b64_tr_b16 v[62:63], v16 offset:31616
    s_waitcnt lgkmcnt(12)
    v_dot2c_f32_bf16 v120, s35, v192
    v_dot2c_f32_bf16 v122, v192, v192
    v_dot2c_f32_bf16 v121, s35, v193
    v_dot2c_f32_bf16 v123, v193, v193
    v_dot2c_f32_bf16 v120, s35, v194
    v_dot2c_f32_bf16 v122, v194, v194
    v_dot2c_f32_bf16 v121, s35, v195
    v_dot2c_f32_bf16 v123, v195, v195
    v_dot2c_f32_bf16 v120, s35, v196
    v_dot2c_f32_bf16 v122, v196, v196
    v_dot2c_f32_bf16 v121, s35, v197
    v_dot2c_f32_bf16 v123, v197, v197
    v_dot2c_f32_bf16 v120, s35, v198
    v_dot2c_f32_bf16 v122, v198, v198
    v_dot2c_f32_bf16 v121, s35, v199
    v_dot2c_f32_bf16 v123, v199, v199
    v_dot2c_f32_bf16 v120, s35, v200
    v_dot2c_f32_bf16 v122, v200, v200
    v_dot2c_f32_bf16 v121, s35, v201
    v_dot2c_f32_bf16 v123, v201, v201
    v_dot2c_f32_bf16 v120, s35, v202
    v_dot2c_f32_bf16 v122, v202, v202
    v_dot2c_f32_bf16 v121, s35, v203
    v_dot2c_f32_bf16 v123, v203, v203
    v_dot2c_f32_bf16 v120, s35, v204
    v_dot2c_f32_bf16 v122, v204, v204
    v_dot2c_f32_bf16 v121, s35, v205
    v_dot2c_f32_bf16 v123, v205, v205
    v_dot2c_f32_bf16 v120, s35, v206
    v_dot2c_f32_bf16 v122, v206, v206
    v_dot2c_f32_bf16 v121, s35, v207
    v_dot2c_f32_bf16 v123, v207, v207
    v_dot2c_f32_bf16 v120, s35, v208
    v_dot2c_f32_bf16 v122, v208, v208
    v_dot2c_f32_bf16 v121, s35, v209
    v_dot2c_f32_bf16 v123, v209, v209
    v_dot2c_f32_bf16 v120, s35, v210
    v_dot2c_f32_bf16 v122, v210, v210
    v_dot2c_f32_bf16 v121, s35, v211
    v_dot2c_f32_bf16 v123, v211, v211
    v_dot2c_f32_bf16 v120, s35, v212
    v_dot2c_f32_bf16 v122, v212, v212
    v_dot2c_f32_bf16 v121, s35, v213
    v_dot2c_f32_bf16 v123, v213, v213
    v_dot2c_f32_bf16 v120, s35, v214
    v_dot2c_f32_bf16 v122, v214, v214
    v_dot2c_f32_bf16 v121, s35, v215
    v_dot2c_f32_bf16 v123, v215, v215
    v_dot2c_f32_bf16 v120, s35, v216
    v_dot2c_f32_bf16 v122, v216, v216
    v_dot2c_f32_bf16 v121, s35, v217
    v_dot2c_f32_bf16 v123, v217, v217
    v_dot2c_f32_bf16 v120, s35, v218
    v_dot2c_f32_bf16 v122, v218, v218
    v_dot2c_f32_bf16 v121, s35, v219
    v_dot2c_f32_bf16 v123, v219, v219
    v_dot2c_f32_bf16 v120, s35, v220
    v_dot2c_f32_bf16 v122, v220, v220
    v_dot2c_f32_bf16 v121, s35, v221
    v_dot2c_f32_bf16 v123, v221, v221
    v_dot2c_f32_bf16 v120, s35, v222
    v_dot2c_f32_bf16 v122, v222, v222
    v_dot2c_f32_bf16 v121, s35, v223
    v_dot2c_f32_bf16 v123, v223, v223
    s_waitcnt lgkmcnt(10)
    v_mfma_f32_32x32x16_bf16 v[64:79], v[40:43], v[160:163], v[64:79]
    ds_read_b64_tr_b16 v[28:29], v16 offset:36864
    ds_read_b64_tr_b16 v[30:31], v16 offset:37632
    v_add_f32 v120, v120, v121
    s_waitcnt lgkmcnt(10)
    v_mfma_f32_32x32x16_bf16 v[80:95], v[44:47], v[160:163], v[80:95]
    ds_read_b64_tr_b16 v[32:33], v16 offset:36928
    ds_read_b64_tr_b16 v[34:35], v16 offset:37696
    v_add_f32 v122, v122, v123
    v_mov_b32 v121, v120
    s_waitcnt lgkmcnt(10)
    v_mfma_f32_32x32x16_bf16 v[96:111], v[48:51], v[160:163], v[96:111]
    ds_read_b64_tr_b16 v[36:37], v16 offset:36992
    ds_read_b64_tr_b16 v[38:39], v16 offset:37760
    v_mov_b32 v123, v122
    s_waitcnt lgkmcnt(10)
    v_mfma_f32_32x32x16_bf16 v[64:79], v[52:55], v[168:171], v[64:79]
    ds_read_b64_tr_b16 v[40:41], v16 offset:43008
    ds_read_b64_tr_b16 v[42:43], v16 offset:43776
    s_nop 0
    v_permlane32_swap_b32 v120, v121
    s_waitcnt lgkmcnt(10)
    v_mfma_f32_32x32x16_bf16 v[80:95], v[56:59], v[168:171], v[80:95]
    ds_read_b64_tr_b16 v[44:45], v16 offset:43072
    ds_read_b64_tr_b16 v[46:47], v16 offset:43840
    v_permlane32_swap_b32 v122, v123
    s_waitcnt lgkmcnt(10)
    v_mfma_f32_32x32x16_bf16 v[96:111], v[60:63], v[168:171], v[96:111]
    ds_read_b64_tr_b16 v[48:49], v16 offset:43136
    ds_read_b64_tr_b16 v[50:51], v16 offset:43904
    v_add_f32 v120, v120, v121
    v_add_f32 v122, v122, v123
    s_waitcnt lgkmcnt(10)
    v_mfma_f32_32x32x16_bf16 v[64:79], v[28:31], v[176:179], v[64:79]
    ds_read_b64_tr_b16 v[52:53], v16 offset:27648
    ds_read_b64_tr_b16 v[54:55], v16 offset:28416
    v_mul_f32 v120, 0xbb000000, v120
    s_waitcnt lgkmcnt(10)
    v_mfma_f32_32x32x16_bf16 v[80:95], v[32:35], v[176:179], v[80:95]
    ds_read_b64_tr_b16 v[56:57], v16 offset:27712
    ds_read_b64_tr_b16 v[58:59], v16 offset:28480
    v_mul_f32 v122, 0x3b000000, v122
    v_fma_f32 v122, -v120, v120, v122
    s_waitcnt lgkmcnt(10)
    v_mfma_f32_32x32x16_bf16 v[96:111], v[36:39], v[176:179], v[96:111]
    s_barrier
    ds_read_b64_tr_b16 v[60:61], v16 offset:27776
    ds_read_b64_tr_b16 v[62:63], v16 offset:28544
    v_max_f32 v122, 0, v122
    s_waitcnt lgkmcnt(10)
    v_mfma_f32_32x32x16_bf16 v[64:79], v[40:43], v[184:187], v[64:79]
    ds_read_b64_tr_b16 v[28:29], v16 offset:33792
    ds_read_b64_tr_b16 v[30:31], v16 offset:34560
    v_add_f32 v122, 0x3727c5ac, v122
    v_rsq_f32 v21, v122
    s_waitcnt lgkmcnt(10)
    v_mfma_f32_32x32x16_bf16 v[80:95], v[44:47], v[184:187], v[80:95]
    ds_read_b64_tr_b16 v[32:33], v16 offset:33856
    ds_read_b64_tr_b16 v[34:35], v16 offset:34624
    v_cvt_pk_bf16_f32 v24, v120, v120
    v_mul_f32 v22, v122, v21
    s_waitcnt lgkmcnt(10)
    v_mfma_f32_32x32x16_bf16 v[96:111], v[48:51], v[184:187], v[96:111]
    ds_read_b64_tr_b16 v[36:37], v16 offset:33920
    ds_read_b64_tr_b16 v[38:39], v16 offset:34688
    v_and_b32 v25, 0xffff0000, v24
    s_waitcnt lgkmcnt(10)
    v_mfma_f32_32x32x16_bf16 v[64:79], v[52:55], v[164:167], v[64:79]
    ds_read_b64_tr_b16 v[40:41], v16 offset:39936
    ds_read_b64_tr_b16 v[42:43], v16 offset:40704
    v_sub_f32 v120, v120, v25
    v_cvt_pk_bf16_f32 v24, v25, v120
    s_waitcnt lgkmcnt(10)
    v_mfma_f32_32x32x16_bf16 v[80:95], v[56:59], v[164:167], v[80:95]
    ds_read_b64_tr_b16 v[44:45], v16 offset:40000
    ds_read_b64_tr_b16 v[46:47], v16 offset:40768
    v_cvt_pk_bf16_f32 v27, v25, v22
    s_waitcnt lgkmcnt(10)
    v_mfma_f32_32x32x16_bf16 v[96:111], v[60:63], v[164:167], v[96:111]
    ds_read_b64_tr_b16 v[48:49], v16 offset:40064
    ds_read_b64_tr_b16 v[50:51], v16 offset:40832
    v_and_b32 v120, 0xffff0000, v27
    v_sub_f32 v120, v22, v120
    s_waitcnt lgkmcnt(10)
    v_mfma_f32_32x32x16_bf16 v[64:79], v[28:31], v[172:175], v[64:79]
    ds_read_b64_tr_b16 v[52:53], v16 offset:46080
    ds_read_b64_tr_b16 v[54:55], v16 offset:46848
    v_cvt_pk_bf16_f32 v26, v25, v120
    s_waitcnt lgkmcnt(10)
    v_mfma_f32_32x32x16_bf16 v[80:95], v[32:35], v[172:175], v[80:95]
    ds_read_b64_tr_b16 v[56:57], v16 offset:46144
    ds_read_b64_tr_b16 v[58:59], v16 offset:46912
    v_and_b32 v122, 0xffff0000, v26
    v_sub_f32 v122, v120, v122
    s_waitcnt lgkmcnt(10)
    v_mfma_f32_32x32x16_bf16 v[96:111], v[36:39], v[172:175], v[96:111]
    ds_read_b64_tr_b16 v[60:61], v16 offset:46208
    ds_read_b64_tr_b16 v[62:63], v16 offset:46976
    v_cvt_pk_bf16_f32 v122, v25, v122
    s_waitcnt lgkmcnt(10)
    v_mfma_f32_32x32x16_bf16 v[64:79], v[40:43], v[180:183], v[64:79]
    s_barrier
    ds_read_b64_tr_b16 v[28:29], v17 offset:0
    ds_read_b64_tr_b16 v[30:31], v17 offset:768
    v_cmp_eq_u32 vcc, 0, v5
    s_nop 1
    v_cndmask_b32 v25, v122, v27, vcc
    s_waitcnt lgkmcnt(10)
    v_mfma_f32_32x32x16_bf16 v[80:95], v[44:47], v[180:183], v[80:95]
    ds_read_b64_tr_b16 v[32:33], v17 offset:6144
    ds_read_b64_tr_b16 v[34:35], v17 offset:6912
    v_mov_b32 v27, v26
    v_mov_b32 v26, v24
    s_waitcnt lgkmcnt(10)
    v_mfma_f32_32x32x16_bf16 v[96:111], v[48:51], v[180:183], v[96:111]
    ds_read_b64_tr_b16 v[36:37], v17 offset:12288
    ds_read_b64_tr_b16 v[38:39], v17 offset:13056
    s_waitcnt lgkmcnt(10)
    v_mfma_f32_32x32x16_bf16 v[64:79], v[52:55], v[188:191], v[64:79]
    ds_read_b64_tr_b16 v[40:41], v17 offset:18432
    ds_read_b64_tr_b16 v[42:43], v17 offset:19200
    s_waitcnt lgkmcnt(10)
    v_mfma_f32_32x32x16_bf16 v[80:95], v[56:59], v[188:191], v[80:95]
    ds_read_b64_tr_b16 v[44:45], v17 offset:3072
    ds_read_b64_tr_b16 v[46:47], v17 offset:3840
    s_waitcnt lgkmcnt(10)
    v_mfma_f32_32x32x16_bf16 v[96:111], v[60:63], v[188:191], v[96:111]
    ds_read_b64_tr_b16 v[48:49], v17 offset:9216
    ds_read_b64_tr_b16 v[50:51], v17 offset:9984
    s_waitcnt lgkmcnt(10)
    v_mfma_f32_32x32x16_bf16 v[64:79], v[28:31], v[192:195], v[64:79]
    ds_read_b64_tr_b16 v[52:53], v17 offset:15360
    ds_read_b64_tr_b16 v[54:55], v17 offset:16128
    s_waitcnt lgkmcnt(10)
    v_mfma_f32_32x32x16_bf16 v[64:79], v[32:35], v[200:203], v[64:79]
    ds_read_b64_tr_b16 v[56:57], v17 offset:21504
    ds_read_b64_tr_b16 v[58:59], v17 offset:22272
    s_waitcnt lgkmcnt(10)
    v_mfma_f32_32x32x16_bf16 v[64:79], v[36:39], v[208:211], v[64:79]
    ds_read_b128 v[60:63], v4 offset:61440
    s_waitcnt lgkmcnt(9)
    v_mfma_f32_32x32x16_bf16 v[64:79], v[40:43], v[216:219], v[64:79]
    ds_read_b64_tr_b16 v[28:29], v17 offset:64
    ds_read_b64_tr_b16 v[30:31], v17 offset:832
    s_waitcnt lgkmcnt(9)
    v_mfma_f32_32x32x16_bf16 v[64:79], v[44:47], v[196:199], v[64:79]
    ds_read_b64_tr_b16 v[32:33], v17 offset:6208
    ds_read_b64_tr_b16 v[34:35], v17 offset:6976
    s_waitcnt lgkmcnt(9)
    v_mfma_f32_32x32x16_bf16 v[64:79], v[48:51], v[204:207], v[64:79]
    ds_read_b64_tr_b16 v[36:37], v17 offset:12352
    ds_read_b64_tr_b16 v[38:39], v17 offset:13120
    s_waitcnt lgkmcnt(9)
    v_mfma_f32_32x32x16_bf16 v[64:79], v[52:55], v[212:215], v[64:79]
    ds_read_b64_tr_b16 v[40:41], v17 offset:18496
    ds_read_b64_tr_b16 v[42:43], v17 offset:19264
    s_waitcnt lgkmcnt(9)
    v_mfma_f32_32x32x16_bf16 v[64:79], v[56:59], v[220:223], v[64:79]
    ds_read_b64_tr_b16 v[44:45], v17 offset:3136
    ds_read_b64_tr_b16 v[46:47], v17 offset:3904
    s_waitcnt lgkmcnt(10)
    v_mfma_f32_32x32x16_bf16 v[64:79], v[60:63], v[24:27], v[64:79]
    ds_read_b64_tr_b16 v[48:49], v17 offset:9280
    ds_read_b64_tr_b16 v[50:51], v17 offset:10048
    s_waitcnt lgkmcnt(10)
    v_mfma_f32_32x32x16_bf16 v[80:95], v[28:31], v[192:195], v[80:95]
    ds_read_b64_tr_b16 v[52:53], v17 offset:15424
    ds_read_b64_tr_b16 v[54:55], v17 offset:16192
    s_waitcnt lgkmcnt(10)
    v_mfma_f32_32x32x16_bf16 v[80:95], v[32:35], v[200:203], v[80:95]
    ds_read_b64_tr_b16 v[56:57], v17 offset:21568
    ds_read_b64_tr_b16 v[58:59], v17 offset:22336
    s_waitcnt lgkmcnt(10)
    v_mfma_f32_32x32x16_bf16 v[80:95], v[36:39], v[208:211], v[80:95]
    ds_read_b128 v[60:63], v4 offset:62464
    s_mul_i32 s30, s93, 3
    s_add_u32 s30, s30, 0
    s_lshr_b32 s31, s30, 4
    s_cmp_eq_u32 s31, 0
    s_cselect_b32 s32, 0x3eb8aa3b, 1.0
    v_mul_f32 v2, s32, v21
    s_lshl_b32 s33, s30, 17
    s_add_u32 s33, s33, s22
    s_waitcnt lgkmcnt(9)
    v_mfma_f32_32x32x16_bf16 v[80:95], v[40:43], v[216:219], v[80:95]
    ds_read_b64_tr_b16 v[28:29], v17 offset:128
    ds_read_b64_tr_b16 v[30:31], v17 offset:896
    s_lshl_b32 s34, s92, 10
    s_add_u32 s33, s33, s34
    s_add_u32 s34, s33, 65536
    v_mul_f32 v64, v2, v64
    v_mul_f32 v65, v2, v65
    v_mul_f32 v66, v2, v66
    s_waitcnt lgkmcnt(9)
    v_mfma_f32_32x32x16_bf16 v[80:95], v[44:47], v[196:199], v[80:95]
    ds_read_b64_tr_b16 v[32:33], v17 offset:6272
    ds_read_b64_tr_b16 v[34:35], v17 offset:7040
    v_mul_f32 v67, v2, v67
    v_mul_f32 v68, v2, v68
    v_mul_f32 v69, v2, v69
    v_mul_f32 v70, v2, v70
    s_waitcnt lgkmcnt(9)
    v_mfma_f32_32x32x16_bf16 v[80:95], v[48:51], v[204:207], v[80:95]
    ds_read_b64_tr_b16 v[36:37], v17 offset:12416
    ds_read_b64_tr_b16 v[38:39], v17 offset:13184
    v_mul_f32 v71, v2, v71
    v_mul_f32 v72, v2, v72
    v_mul_f32 v73, v2, v73
    v_mul_f32 v74, v2, v74
    v_mul_f32 v75, v2, v75
    s_waitcnt lgkmcnt(9)
    v_mfma_f32_32x32x16_bf16 v[80:95], v[52:55], v[212:215], v[80:95]
    ds_read_b64_tr_b16 v[40:41], v17 offset:18560
    ds_read_b64_tr_b16 v[42:43], v17 offset:19328
    v_mul_f32 v76, v2, v76
    v_mul_f32 v77, v2, v77
    v_mul_f32 v78, v2, v78
    v_mul_f32 v79, v2, v79
    s_waitcnt lgkmcnt(9)
    v_mfma_f32_32x32x16_bf16 v[80:95], v[56:59], v[220:223], v[80:95]
    ds_read_b64_tr_b16 v[44:45], v17 offset:3200
    ds_read_b64_tr_b16 v[46:47], v17 offset:3968
    v_cvt_pk_bf16_f32 v112, v64, v65
    v_cvt_pk_bf16_f32 v113, v66, v67
    v_cvt_pk_bf16_f32 v114, v68, v69
    v_cvt_pk_bf16_f32 v115, v70, v71
    s_waitcnt lgkmcnt(10)
    v_mfma_f32_32x32x16_bf16 v[80:95], v[60:63], v[24:27], v[80:95]
    ds_read_b64_tr_b16 v[48:49], v17 offset:9344
    ds_read_b64_tr_b16 v[50:51], v17 offset:10112
    v_cvt_pk_bf16_f32 v116, v72, v73
    v_cvt_pk_bf16_f32 v117, v74, v75
    v_cvt_pk_bf16_f32 v118, v76, v77
    v_cvt_pk_bf16_f32 v119, v78, v79
    s_cmp_eq_u32 s31, 2
    s_cbranch_scc1 Lv_5
    buffer_store_dwordx4 v[112:115], v4, s[12:15], s33 offen sc1
    buffer_store_dwordx4 v[116:119], v4, s[12:15], s34 offen sc1
Le_6:
    s_waitcnt lgkmcnt(10)
    v_mfma_f32_32x32x16_bf16 v[96:111], v[28:31], v[192:195], v[96:111]
    ds_read_b64_tr_b16 v[52:53], v17 offset:15488
    ds_read_b64_tr_b16 v[54:55], v17 offset:16256
    s_waitcnt lgkmcnt(10)
    v_mfma_f32_32x32x16_bf16 v[96:111], v[32:35], v[200:203], v[96:111]
    ds_read_b64_tr_b16 v[56:57], v17 offset:21632
    ds_read_b64_tr_b16 v[58:59], v17 offset:22400
    s_waitcnt lgkmcnt(10)
    v_mfma_f32_32x32x16_bf16 v[96:111], v[36:39], v[208:211], v[96:111]
    ds_read_b128 v[60:63], v4 offset:63488
    s_mul_i32 s30, s93, 3
    s_add_u32 s30, s30, 1
    s_lshr_b32 s31, s30, 4
    s_cmp_eq_u32 s31, 0
    s_cselect_b32 s32, 0x3eb8aa3b, 1.0
    v_mul_f32 v2, s32, v21
    s_lshl_b32 s33, s30, 17
    s_add_u32 s33, s33, s22
    s_waitcnt lgkmcnt(9)
    v_mfma_f32_32x32x16_bf16 v[96:111], v[40:43], v[216:219], v[96:111]
    s_lshl_b32 s34, s92, 10
    s_add_u32 s33, s33, s34
    s_add_u32 s34, s33, 65536
    v_mul_f32 v80, v2, v80
    v_mul_f32 v81, v2, v81
    v_mul_f32 v82, v2, v82
    s_waitcnt lgkmcnt(7)
    v_mfma_f32_32x32x16_bf16 v[96:111], v[44:47], v[196:199], v[96:111]
    v_mul_f32 v83, v2, v83
    v_mul_f32 v84, v2, v84
    v_mul_f32 v85, v2, v85
    v_mul_f32 v86, v2, v86
    s_waitcnt lgkmcnt(5)
    v_mfma_f32_32x32x16_bf16 v[96:111], v[48:51], v[204:207], v[96:111]
    v_mul_f32 v87, v2, v87
    v_mul_f32 v88, v2, v88
    v_mul_f32 v89, v2, v89
    v_mul_f32 v90, v2, v90
    v_mul_f32 v91, v2, v91
    s_waitcnt lgkmcnt(3)
    v_mfma_f32_32x32x16_bf16 v[96:111], v[52:55], v[212:215], v[96:111]
    v_mul_f32 v92, v2, v92
    v_mul_f32 v93, v2, v93
    v_mul_f32 v94, v2, v94
    v_mul_f32 v95, v2, v95
    s_waitcnt lgkmcnt(1)
    v_mfma_f32_32x32x16_bf16 v[96:111], v[56:59], v[220:223], v[96:111]
    v_cvt_pk_bf16_f32 v120, v80, v81
    v_cvt_pk_bf16_f32 v121, v82, v83
    v_cvt_pk_bf16_f32 v122, v84, v85
    v_cvt_pk_bf16_f32 v123, v86, v87
    s_waitcnt lgkmcnt(0)
    v_mfma_f32_32x32x16_bf16 v[96:111], v[60:63], v[24:27], v[96:111]
    v_cvt_pk_bf16_f32 v124, v88, v89
    v_cvt_pk_bf16_f32 v125, v90, v91
    v_cvt_pk_bf16_f32 v126, v92, v93
    v_cvt_pk_bf16_f32 v127, v94, v95
    s_cmp_eq_u32 s31, 2
    s_cbranch_scc1 Lv_7
    buffer_store_dwordx4 v[120:123], v4, s[12:15], s33 offen sc1
    buffer_store_dwordx4 v[124:127], v4, s[12:15], s34 offen sc1
Le_8:
    s_barrier
    s_mul_i32 s30, s93, 3
    s_add_u32 s30, s30, 2
    s_lshr_b32 s31, s30, 4
    s_cmp_eq_u32 s31, 0
    s_cselect_b32 s32, 0x3eb8aa3b, 1.0
    v_mul_f32 v2, s32, v21
    s_lshl_b32 s33, s30, 17
    s_add_u32 s33, s33, s22
    s_lshl_b32 s34, s92, 10
    s_add_u32 s33, s33, s34
    s_add_u32 s34, s33, 65536
    v_mul_f32 v96, v2, v96
    v_mul_f32 v97, v2, v97
    v_mul_f32 v98, v2, v98
    v_mul_f32 v99, v2, v99
    v_mul_f32 v100, v2, v100
    v_mul_f32 v101, v2, v101
    v_mul_f32 v102, v2, v102
    v_mul_f32 v103, v2, v103
    v_mul_f32 v104, v2, v104
    v_mul_f32 v105, v2, v105
    v_mul_f32 v106, v2, v106
    v_mul_f32 v107, v2, v107
    v_mul_f32 v108, v2, v108
    v_mul_f32 v109, v2, v109
    v_mul_f32 v110, v2, v110
    v_mul_f32 v111, v2, v111
    v_cvt_pk_bf16_f32 v112, v96, v97
    v_cvt_pk_bf16_f32 v113, v98, v99
    v_cvt_pk_bf16_f32 v114, v100, v101
    v_cvt_pk_bf16_f32 v115, v102, v103
    v_cvt_pk_bf16_f32 v116, v104, v105
    v_cvt_pk_bf16_f32 v117, v106, v107
    v_cvt_pk_bf16_f32 v118, v108, v109
    v_cvt_pk_bf16_f32 v119, v110, v111
    s_cmp_eq_u32 s31, 2
    s_cbranch_scc1 Lv_9
    buffer_store_dwordx4 v[112:115], v4, s[12:15], s33 offen sc1
    buffer_store_dwordx4 v[116:119], v4, s[12:15], s34 offen sc1
Le_10:
    s_nop 1
    v_mov_b32 v7, 162816
    s_setprio 0
    s_waitcnt vmcnt(0)
    s_barrier
    s_barrier
    ds_read_b64 v[2:3], v7 offset:256
    s_waitcnt lgkmcnt(0)
    v_readfirstlane_b32 s8, v2
    v_readfirstlane_b32 s9, v3
    s_nop 4
mega_layer:
    s_lshl_b32 s40, s23, 2
    s_and_b32 s30, s24, 3
    s_add_u32 s40, s40, s30
    s_lshr_b32 s41, s24, 2
    s_lshl_b32 s41, s41, 3
    s_lshl_b32 s30, s21, 1
    s_add_u32 s41, s41, s30
    s_lshl_b32 s42, s40, 16
    s_add_u32 s42, s42, s22
    v_and_b32 v2, 11, v0
    v_cmp_eq_u32 vcc, 0, v2
    v_mov_b32 v3, 0x3f803f80
    s_nop 0
    v_cndmask_b32 v20, 0, v3, vcc
    v_cndmask_b32 v21, 0, v3, vcc
    v_cndmask_b32 v22, 0, v3, vcc
    v_cndmask_b32 v23, 0, v3, vcc
    v_lshlrev_b32 v2, 4, v0
    v_add_u32 v2, 131072, v2
    ds_write_b128 v2, v[20:23]
    ds_write_b128 v2, v[20:23] offset:2048
    v_mov_b32 v2, 162816
    v_mov_b32 v28, 0
    ds_write_b32 v2, v28 offset:4
    s_mov_b32 s26, 0
    s_lshr_b32 s30, s40, 1
    v_lshrrev_b32 v19, 4, v1
    v_lshl_add_u32 v19, v19, 4, s30
    v_mul_u32_u24 v19, 43691, v19
    v_lshrrev_b32 v19, 17, v19
    v_lshlrev_b32 v19, 9, v19
    v_and_b32 v2, 15, v1
    v_lshl_add_u32 v19, v2, 3, v19
    s_add_u32 s31, s22, 0x1300000
    s_cmp_eq_u32 s20, 4
    s_cbranch_scc1 Lpol_19
    v_mov_b32 v3, 162824
    s_add_u32 s29, s29, 1
Loth_22:
    ds_read_b32 v2, v3
    s_waitcnt lgkmcnt(0)
    v_cmp_gt_u32 vcc, s29, v2
    s_nop 4
    s_cbranch_vccnz Loth_22
Lrel_20:
    s_lshl_b32 s30, s20, 10
    s_add_u32 s31, s42, s30
    s_add_u32 s32, s31, 0x400000
    s_add_u32 s31, s31, 0x200000
    s_mov_b32 m0, s30
    s_nop 0
    buffer_load_dwordx4 v4, s[12:15], s31 offen sc1 lds
    s_add_u32 m0, s30, 65536
    s_nop 0
    buffer_load_dwordx4 v4, s[12:15], s32 offen sc1 lds
    s_cmp_ge_u32 s20, 4
    s_cbranch_scc1 Lcomp_11
    s_lshl_b32 s34, s21, 10
    s_add_u32 s36, s34, s42
    s_waitcnt vmcnt(0) lgkmcnt(0)
    s_barrier
    s_add_u32 m0, s34, 8192
    s_add_u32 s35, s36, 0x202000
    buffer_load_dwordx4 v4, s[12:15], s35 offen sc1 lds
    s_add_u32 m0, s34, 73728
    s_add_u32 s35, s36, 0x402000
    buffer_load_dwordx4 v4, s[12:15], s35 offen sc1 lds
    s_add_u32 m0, s34, 12288
    s_add_u32 s35, s36, 0x203000
    buffer_load_dwordx4 v4, s[12:15], s35 offen sc1 lds
    s_add_u32 m0, s34, 77824
    s_add_u32 s35, s36, 0x403000
    buffer_load_dwordx4 v4, s[12:15], s35 offen sc1 lds
    s_add_u32 m0, s34, 16384
    s_add_u32 s35, s36, 0x204000
    buffer_load_dwordx4 v4, s[12:15], s35 offen sc1 lds
    s_add_u32 m0, s34, 81920
    s_add_u32 s35, s36, 0x404000
    buffer_load_dwordx4 v4, s[12:15], s35 offen sc1 lds
    s_add_u32 m0, s34, 20480
    s_add_u32 s35, s36, 0x205000
    buffer_load_dwordx4 v4, s[12:15], s35 offen sc1 lds
    s_add_u32 m0, s34, 86016
    s_add_u32 s35, s36, 0x405000
    buffer_load_dwordx4 v4, s[12:15], s35 offen sc1 lds
    s_add_u32 m0, s34, 24576
    s_add_u32 s35, s36, 0x206000
    buffer_load_dwordx4 v4, s[12:15], s35 offen sc1 lds
    s_add_u32 m0, s34, 90112
    s_add_u32 s35, s36, 0x406000
    buffer_load_dwordx4 v4, s[12:15], s35 offen sc1 lds
    s_add_u32 m0, s34, 28672
    s_add_u32 s35, s36, 0x207000
    buffer_load_dwordx4 v4, s[12:15], s35 offen sc1 lds
    s_add_u32 m0, s34, 94208
    s_add_u32 s35, s36, 0x407000
    buffer_load_dwordx4 v4, s[12:15], s35 offen sc1 lds
    s_add_u32 m0, s34, 32768
    s_add_u32 s35, s36, 0x208000
    buffer_load_dwordx4 v4, s[12:15], s35 offen sc1 lds
    s_add_u32 m0, s34, 98304
    s_add_u32 s35, s36, 0x408000
    buffer_load_dwordx4 v4, s[12:15], s35 offen sc1 lds
    s_add_u32 m0, s34, 36864
    s_add_u32 s35, s36, 0x209000
    buffer_load_dwordx4 v4, s[12:15], s35 offen sc1 lds
    s_add_u32 m0, s34, 102400
    s_add_u32 s35, s36, 0x409000
    buffer_load_dwordx4 v4, s[12:15], s35 offen sc1 lds
    s_add_u32 m0, s34, 40960
    s_add_u32 s35, s36, 0x20a000
    buffer_load_dwordx4 v4, s[12:15], s35 offen sc1 lds
    s_add_u32 m0, s34, 106496
    s_add_u32 s35, s36, 0x40a000
    buffer_load_dwordx4 v4, s[12:15], s35 offen sc1 lds
    s_add_u32 m0, s34, 45056
    s_add_u32 s35, s36, 0x20b000
    buffer_load_dwordx4 v4, s[12:15], s35 offen sc1 lds
    s_add_u32 m0, s34, 110592
    s_add_u32 s35, s36, 0x40b000
    buffer_load_dwordx4 v4, s[12:15], s35 offen sc1 lds
    s_add_u32 m0, s34, 49152
    s_add_u32 s35, s36, 0x20c000
    buffer_load_dwordx4 v4, s[12:15], s35 offen sc1 lds
    s_add_u32 m0, s34, 114688
    s_add_u32 s35, s36, 0x40c000
    buffer_load_dwordx4 v4, s[12:15], s35 offen sc1 lds
    s_add_u32 m0, s34, 53248
    s_add_u32 s35, s36, 0x20d000
    buffer_load_dwordx4 v4, s[12:15], s35 offen sc1 lds
    s_add_u32 m0, s34, 118784
    s_add_u32 s35, s36, 0x40d000
    buffer_load_dwordx4 v4, s[12:15], s35 offen sc1 lds
    s_add_u32 m0, s34, 57344
    s_add_u32 s35, s36, 0x20e000
    buffer_load_dwordx4 v4, s[12:15], s35 offen sc1 lds
    s_add_u32 m0, s34, 122880
    s_add_u32 s35, s36, 0x40e000
    buffer_load_dwordx4 v4, s[12:15], s35 offen sc1 lds
    s_add_u32 m0, s34, 61440
    s_add_u32 s35, s36, 0x20f000
    buffer_load_dwordx4 v4, s[12:15], s35 offen sc1 lds
    s_add_u32 m0, s34, 126976
    s_add_u32 s35, s36, 0x40f000
    buffer_load_dwordx4 v4, s[12:15], s35 offen sc1 lds
    s_waitcnt vmcnt(20)
    s_barrier
    v_lshrrev_b32 v2, 3, v1
    v_lshlrev_b32 v2, 10, v2
    v_and_or_b32 v2, v4, s101, v2
    s_lshr_b32 s30, s24, 2
    s_lshl_b32 s30, s30, 7
    s_lshr_b32 s31, s21, 1
    s_lshl_b32 s32, s31, 18
    s_add_u32 s30, s30, s32
    buffer_load_dwordx4 v[128:131], v2, s[44:47], s30 offen
    s_add_u32 s30, s30, 8192
    buffer_load_dwordx4 v[132:135], v2, s[44:47], s30 offen
    s_add_u32 s30, s30, 8192
    buffer_load_dwordx4 v[136:139], v2, s[44:47], s30 offen
    s_add_u32 s30, s30, 8192
    buffer_load_dwordx4 v[140:143], v2, s[44:47], s30 offen
    s_add_u32 s30, s30, 8192
    buffer_load_dwordx4 v[144:147], v2, s[44:47], s30 offen
    s_add_u32 s30, s30, 8192
    buffer_load_dwordx4 v[148:151], v2, s[44:47], s30 offen
    s_add_u32 s30, s30, 8192
    buffer_load_dwordx4 v[152:155], v2, s[44:47], s30 offen
    s_add_u32 s30, s30, 8192
    buffer_load_dwordx4 v[156:159], v2, s[44:47], s30 offen
    s_add_u32 s30, s30, 8192
    buffer_load_dwordx4 v[160:163], v2, s[44:47], s30 offen
    s_add_u32 s30, s30, 8192
    buffer_load_dwordx4 v[164:167], v2, s[44:47], s30 offen
    s_add_u32 s30, s30, 8192
    buffer_load_dwordx4 v[168:171], v2, s[44:47], s30 offen
    s_add_u32 s30, s30, 8192
    buffer_load_dwordx4 v[172:175], v2, s[44:47], s30 offen
    s_add_u32 s30, s30, 8192
    buffer_load_dwordx4 v[176:179], v2, s[44:47], s30 offen
    s_add_u32 s30, s30, 8192
    buffer_load_dwordx4 v[180:183], v2, s[44:47], s30 offen
    s_add_u32 s30, s30, 8192
    buffer_load_dwordx4 v[184:187], v2, s[44:47], s30 offen
    s_add_u32 s30, s30, 8192
    buffer_load_dwordx4 v[188:191], v2, s[44:47], s30 offen
    s_add_u32 s30, s30, 8192
    buffer_load_dwordx4 v[192:195], v2, s[44:47], s30 offen
    s_add_u32 s30, s30, 8192
    buffer_load_dwordx4 v[196:199], v2, s[44:47], s30 offen
    s_add_u32 s30, s30, 8192
    buffer_load_dwordx4 v[200:203], v2, s[44:47], s30 offen
    s_add_u32 s30, s30, 8192
    buffer_load_dwordx4 v[204:207], v2, s[44:47], s30 offen
    s_add_u32 s30, s30, 8192
    buffer_load_dwordx4 v[208:211], v2, s[44:47], s30 offen
    s_add_u32 s30, s30, 8192
    buffer_load_dwordx4 v[212:215], v2, s[44:47], s30 offen
    s_add_u32 s30, s30, 8192
    buffer_load_dwordx4 v[216:219], v2, s[44:47], s30 offen
    s_add_u32 s30, s30, 8192
    buffer_load_dwordx4 v[220:223], v2, s[44:47], s30 offen
    s_add_u32 s30, s30, 8192
    buffer_load_dwordx4 v[224:227], v2, s[44:47], s30 offen
    s_add_u32 s30, s30, 8192
    buffer_load_dwordx4 v[228:231], v2, s[44:47], s30 offen
    s_add_u32 s30, s30, 8192
    buffer_load_dwordx4 v[232:235], v2, s[44:47], s30 offen
    s_add_u32 s30, s30, 8192
    buffer_load_dwordx4 v[236:239], v2, s[44:47], s30 offen
    s_add_u32 s30, s30, 8192
    buffer_load_dwordx4 v[240:243], v2, s[44:47], s30 offen
    s_add_u32 s30, s30, 8192
    buffer_load_dwordx4 v[244:247], v2, s[44:47], s30 offen
    s_add_u32 s30, s30, 8192
    buffer_load_dwordx4 v[248:251], v2, s[44:47], s30 offen
    s_add_u32 s30, s30, 8192
    buffer_load_dwordx4 v[252:255], v2, s[44:47], s30 offen
    s_add_u32 s30, s30, 8192
    s_waitcnt vmcnt(32)
    s_barrier
    s_lshr_b32 s38, s24, 1
    v_add_u32 v2, 0, v1
    v_mul_u32_u24 v3, 43691, v2
    v_lshrrev_b32 v3, 19, v3
    v_mul_u32_u24 v16, 12, v3
    v_sub_u32 v2, v2, v16
    v_mul_u32_u24 v3, 2752, v3
    v_lshl_add_u32 v16, v2, 4, v3
    v_add_u32 v2, 64, v1
    v_mul_u32_u24 v3, 43691, v2
    v_lshrrev_b32 v3, 19, v3
    v_mul_u32_u24 v17, 12, v3
    v_sub_u32 v2, v2, v17
    v_mul_u32_u24 v3, 2752, v3
    v_lshl_add_u32 v17, v2, 4, v3
    v_subrev_u32 v17, 1024, v17
    v_add_u32 v2, 128, v1
    v_mul_u32_u24 v3, 43691, v2
    v_lshrrev_b32 v3, 19, v3
    v_mul_u32_u24 v18, 12, v3
    v_sub_u32 v2, v2, v18
    v_mul_u32_u24 v3, 2752, v3
    v_lshl_add_u32 v18, v2, 4, v3
    v_subrev_u32 v18, 2048, v18
    s_mul_i32 s36, s38, 192
    s_mul_i32 s37, s21, 88064
    s_add_u32 s36, s36, s37
    s_mul_i32 s37, s21, 6144
    s_add_u32 s37, s37, 64512
    s_add_u32 s35, s36, 0
    buffer_load_dwordx4 v[32:35], v16, s[48:51], s35 offen
    buffer_load_dwordx4 v[36:39], v17, s[48:51], s35 offen offset:1024
    buffer_load_dwordx4 v[40:43], v18, s[48:51], s35 offen offset:2048
    s_add_u32 s35, s36, 44032
    buffer_load_dwordx4 v[44:47], v16, s[48:51], s35 offen
    buffer_load_dwordx4 v[48:51], v17, s[48:51], s35 offen offset:1024
    buffer_load_dwordx4 v[52:55], v18, s[48:51], s35 offen offset:2048
    s_add_u32 s35, s36, 352256
    buffer_load_dwordx4 v[56:59], v16, s[48:51], s35 offen
    buffer_load_dwordx4 v[60:63], v17, s[48:51], s35 offen offset:1024
    buffer_load_dwordx4 v[64:67], v18, s[48:51], s35 offen offset:2048
    s_add_u32 s35, s36, 396288
    buffer_load_dwordx4 v[68:71], v16, s[48:51], s35 offen
    buffer_load_dwordx4 v[72:75], v17, s[48:51], s35 offen offset:1024
    buffer_load_dwordx4 v[76:79], v18, s[48:51], s35 offen offset:2048
    s_add_u32 s35, s36, 704512
    buffer_load_dwordx4 v[80:83], v16, s[48:51], s35 offen
    buffer_load_dwordx4 v[84:87], v17, s[48:51], s35 offen offset:1024
    buffer_load_dwordx4 v[88:91], v18, s[48:51], s35 offen offset:2048
    s_add_u32 s35, s36, 748544
    buffer_load_dwordx4 v[92:95], v16, s[48:51], s35 offen
    buffer_load_dwordx4 v[96:99], v17, s[48:51], s35 offen offset:1024
    buffer_load_dwordx4 v[100:103], v18, s[48:51], s35 offen offset:2048
    s_add_u32 s35, s36, 1056768
    buffer_load_dwordx4 v[104:107], v16, s[48:51], s35 offen
    buffer_load_dwordx4 v[108:111], v17, s[48:51], s35 offen offset:1024
    buffer_load_dwordx4 v[112:115], v18, s[48:51], s35 offen offset:2048
    s_add_u32 s35, s36, 1100800
    buffer_load_dwordx4 v[116:119], v16, s[48:51], s35 offen
    buffer_load_dwordx4 v[120:123], v17, s[48:51], s35 offen offset:1024
    buffer_load_dwordx4 v[124:127], v18, s[48:51], s35 offen offset:2048
    s_cmp_lg_u32 s22, 0
    s_cbranch_scc1 Lnox_23
    s_lshl_b32 s32, s23, 2
    s_and_b32 s33, s24, 3
    s_add_u32 s32, s32, s33
    s_lshl_b32 s32, s32, 1
    s_and_b32 s33, s21, 1
    s_add_u32 s32, s32, s33
    s_lshr_b32 s33, s24, 2
    s_lshr_b32 s34, s21, 1
    s_lshl_b32 s35, s33, 1
    s_add_u32 s35, s35, s34
    v_and_b32 v2, 31, v1
    v_lshlrev_b32 v2, 10, v2
    v_lshl_add_u32 v2, v5, 3, v2
    s_lshl_b32 s30, s32, 15
    s_lshl_b32 s31, s35, 6
    s_add_u32 s30, s30, s31
    buffer_load_dwordx2 v[8:9], v2, s[4:7], s30 offen offset:0
    buffer_load_dwordx2 v[10:11], v2, s[4:7], s30 offen offset:16
    buffer_load_dwordx2 v[12:13], v2, s[4:7], s30 offen offset:32
    buffer_load_dwordx2 v[14:15], v2, s[4:7], s30 offen offset:48
    s_getpc_b64 s[30:31]
Lpc_25:
    s_sub_u32 s30, s30, Lpc_25-code_start
    s_subb_u32 s31, s31, 0
    s_lshl_b32 s32, s24, 2
    s_add_u32 s32, s32, s21
    s_lshl_b32 s32, s32, 9
    v_lshl_add_u32 v23, v1, 3, s32
    v_min_u32 v23, code_end-code_start-4, v23
    global_load_dword v23, v23, s[30:31]
    s_nop 3
Lnox_23:
    v_lshlrev_b32 v25, 7, v1
    s_lshl_b32 s30, s24, 2
    s_add_u32 s30, s30, s21
    s_mul_i32 s31, s30, 11008
    s_add_u32 s32, s31, 5504
    s_mov_b32 exec_lo, 0xffffffff
    s_mov_b32 exec_hi, 0x7ff
    buffer_load_dword v24, v25, s[52:55], s31 offen sc1
    s_mov_b32 exec_lo, 0xffffffff
    s_mov_b32 exec_hi, 0x7ff
    buffer_load_dword v24, v25, s[52:55], s32 offen sc1
    s_lshl_b32 s31, s23, 7
    s_add_u32 s30, s30, s31
    s_mul_i32 s31, s30, 2048
    s_add_u32 s31, s31, s22
    s_add_u32 s31, s31, 0x800000
    s_mov_b32 exec_lo, 0xffff
    s_mov_b32 exec_hi, 0x0
    buffer_load_dword v24, v25, s[12:15], s31 offen sc1
    s_mul_i32 s31, s30, 256
    s_add_u32 s31, s31, s22
    s_add_u32 s31, s31, 0x1200000
    s_mov_b32 exec_lo, 0x3
    s_mov_b32 exec_hi, 0x0
    buffer_load_dword v24, v25, s[12:15], s31 offen sc1
    s_mul_i32 s31, s30, 5504
    s_add_u32 s31, s31, s22
    s_add_u32 s31, s31, 0xc00000
    s_mov_b32 exec_lo, 0xffffffff
    s_mov_b32 exec_hi, 0x7ff
    buffer_load_dword v24, v25, s[12:15], s31 offen sc1
    s_mul_i32 s31, s30, 2048
    s_add_u32 s31, s31, s22
    s_add_u32 s31, s31, 0xa00000
    s_mov_b32 exec_lo, 0xffff
    s_mov_b32 exec_hi, 0x0
    buffer_load_dword v24, v25, s[12:15], s31 offen sc1
    s_mul_i32 s31, s30, 256
    s_add_u32 s31, s31, s22
    s_add_u32 s31, s31, 0x1280000
    s_mov_b32 exec_lo, 0x3
    s_mov_b32 exec_hi, 0x0
    buffer_load_dword v24, v25, s[12:15], s31 offen sc1
    s_lshl_b32 s31, s23, 10
    s_add_u32 s31, s31, s22
    s_add_u32 s31, s31, 0x1300000
    s_add_u32 s32, s31, 16384
    s_mov_b32 exec_lo, 0xff
    s_mov_b32 exec_hi, 0x0
    buffer_load_dword v24, v25, s[12:15], s32 offen sc1
    s_add_u32 s32, s31, 24576
    s_mov_b32 exec_lo, 0xff
    s_mov_b32 exec_hi, 0x0
    buffer_load_dword v24, v25, s[12:15], s32 offen sc1
    s_add_u32 s32, s31, 49152
    s_mov_b32 exec_lo, 0xff
    s_mov_b32 exec_hi, 0x0
    buffer_load_dword v24, v25, s[12:15], s32 offen sc1
    s_mov_b64 exec, -1
    v_mov_b32 v22, v3
    v_bfe_u32 v2, v1, 2, 2
    v_lshl_add_u32 v2, v5, 2, v2
    v_mul_u32_u24 v2, 128, v2
    v_bfe_u32 v3, v1, 4, 1
    v_lshl_add_u32 v2, v3, 5, v2
    v_and_b32 v3, 3, v1
    v_lshl_add_u32 v20, v3, 3, v2
    v_mov_b32 v3, v22
    s_lshl_b32 s30, s21, 11
    s_add_u32 s30, s30, 143360
    v_add_u32 v21, s30, v4
    s_lshr_b32 s31, s21, 1
    s_lshl_b32 s31, s31, 6
    s_add_u32 s30, s30, s31
    v_add_u32 v20, s30, v20
    v_xor_b32 v22, 64, v20
    s_waitcnt vmcnt(34)
    ds_write_b128 v21, v[128:131] offset:0
    ds_write_b128 v21, v[132:135] offset:1024
    ds_read_b64_tr_b16 v[128:129], v20 offset:0
    ds_read_b64_tr_b16 v[130:131], v20 offset:1024
    ds_read_b64_tr_b16 v[132:133], v22 offset:0
    ds_read_b64_tr_b16 v[134:135], v22 offset:1024
    ds_write_b128 v21, v[136:139] offset:0
    ds_write_b128 v21, v[140:143] offset:1024
    ds_read_b64_tr_b16 v[136:137], v20 offset:0
    ds_read_b64_tr_b16 v[138:139], v20 offset:1024
    ds_read_b64_tr_b16 v[140:141], v22 offset:0
    ds_read_b64_tr_b16 v[142:143], v22 offset:1024
    ds_write_b128 v21, v[144:147] offset:0
    ds_write_b128 v21, v[148:151] offset:1024
    ds_read_b64_tr_b16 v[144:145], v20 offset:0
    ds_read_b64_tr_b16 v[146:147], v20 offset:1024
    ds_read_b64_tr_b16 v[148:149], v22 offset:0
    ds_read_b64_tr_b16 v[150:151], v22 offset:1024
    ds_write_b128 v21, v[152:155] offset:0
    ds_write_b128 v21, v[156:159] offset:1024
    ds_read_b64_tr_b16 v[152:153], v20 offset:0
    ds_read_b64_tr_b16 v[154:155], v20 offset:1024
    ds_read_b64_tr_b16 v[156:157], v22 offset:0
    ds_read_b64_tr_b16 v[158:159], v22 offset:1024
    ds_write_b128 v21, v[160:163] offset:0
    ds_write_b128 v21, v[164:167] offset:1024
    ds_read_b64_tr_b16 v[160:161], v20 offset:0
    ds_read_b64_tr_b16 v[162:163], v20 offset:1024
    ds_read_b64_tr_b16 v[164:165], v22 offset:0
    ds_read_b64_tr_b16 v[166:167], v22 offset:1024
    ds_write_b128 v21, v[168:171] offset:0
    ds_write_b128 v21, v[172:175] offset:1024
    ds_read_b64_tr_b16 v[168:169], v20 offset:0
    ds_read_b64_tr_b16 v[170:171], v20 offset:1024
    ds_read_b64_tr_b16 v[172:173], v22 offset:0
    ds_read_b64_tr_b16 v[174:175], v22 offset:1024
    ds_write_b128 v21, v[176:179] offset:0
    ds_write_b128 v21, v[180:183] offset:1024
    ds_read_b64_tr_b16 v[176:177], v20 offset:0
    ds_read_b64_tr_b16 v[178:179], v20 offset:1024
    ds_read_b64_tr_b16 v[180:181], v22 offset:0
    ds_read_b64_tr_b16 v[182:183], v22 offset:1024
    ds_write_b128 v21, v[184:187] offset:0
    ds_write_b128 v21, v[188:191] offset:1024
    ds_read_b64_tr_b16 v[184:185], v20 offset:0
    ds_read_b64_tr_b16 v[186:187], v20 offset:1024
    ds_read_b64_tr_b16 v[188:189], v22 offset:0
    ds_read_b64_tr_b16 v[190:191], v22 offset:1024
    ds_write_b128 v21, v[192:195] offset:0
    ds_write_b128 v21, v[196:199] offset:1024
    ds_read_b64_tr_b16 v[192:193], v20 offset:0
    ds_read_b64_tr_b16 v[194:195], v20 offset:1024
    ds_read_b64_tr_b16 v[196:197], v22 offset:0
    ds_read_b64_tr_b16 v[198:199], v22 offset:1024
    ds_write_b128 v21, v[200:203] offset:0
    ds_write_b128 v21, v[204:207] offset:1024
    ds_read_b64_tr_b16 v[200:201], v20 offset:0
    ds_read_b64_tr_b16 v[202:203], v20 offset:1024
    ds_read_b64_tr_b16 v[204:205], v22 offset:0
    ds_read_b64_tr_b16 v[206:207], v22 offset:1024
    ds_write_b128 v21, v[208:211] offset:0
    ds_write_b128 v21, v[212:215] offset:1024
    ds_read_b64_tr_b16 v[208:209], v20 offset:0
    ds_read_b64_tr_b16 v[210:211], v20 offset:1024
    ds_read_b64_tr_b16 v[212:213], v22 offset:0
    ds_read_b64_tr_b16 v[214:215], v22 offset:1024
    ds_write_b128 v21, v[216:219] offset:0
    ds_write_b128 v21, v[220:223] offset:1024
    ds_read_b64_tr_b16 v[216:217], v20 offset:0
    ds_read_b64_tr_b16 v[218:219], v20 offset:1024
    ds_read_b64_tr_b16 v[220:221], v22 offset:0
    ds_read_b64_tr_b16 v[222:223], v22 offset:1024
    ds_write_b128 v21, v[224:227] offset:0
    ds_write_b128 v21, v[228:231] offset:1024
    ds_read_b64_tr_b16 v[224:225], v20 offset:0
    ds_read_b64_tr_b16 v[226:227], v20 offset:1024
    ds_read_b64_tr_b16 v[228:229], v22 offset:0
    ds_read_b64_tr_b16 v[230:231], v22 offset:1024
    ds_write_b128 v21, v[232:235] offset:0
    ds_write_b128 v21, v[236:239] offset:1024
    ds_read_b64_tr_b16 v[232:233], v20 offset:0
    ds_read_b64_tr_b16 v[234:235], v20 offset:1024
    ds_read_b64_tr_b16 v[236:237], v22 offset:0
    ds_read_b64_tr_b16 v[238:239], v22 offset:1024
    ds_write_b128 v21, v[240:243] offset:0
    ds_write_b128 v21, v[244:247] offset:1024
    ds_read_b64_tr_b16 v[240:241], v20 offset:0
    ds_read_b64_tr_b16 v[242:243], v20 offset:1024
    ds_read_b64_tr_b16 v[244:245], v22 offset:0
    ds_read_b64_tr_b16 v[246:247], v22 offset:1024
    ds_write_b128 v21, v[248:251] offset:0
    ds_write_b128 v21, v[252:255] offset:1024
    ds_read_b64_tr_b16 v[248:249], v20 offset:0
    ds_read_b64_tr_b16 v[250:251], v20 offset:1024
    ds_read_b64_tr_b16 v[252:253], v22 offset:0
    ds_read_b64_tr_b16 v[254:255], v22 offset:1024
    s_waitcnt lgkmcnt(0)
    s_cmp_lg_u32 s22, 0
    s_cbranch_scc1 Lnox_24
    s_lshl_b32 s31, s23, 9
    s_add_u32 s31, s31, 0x130e000
    v_and_b32 v7, 31, v1
    v_lshlrev_b32 v7, 3, v7
    s_mov_b32 s28, 0x10000
    s_nop 3
Lxpoll_27:
    buffer_load_dwordx2 v[2:3], v7, s[12:15], s31 offen sc1
    s_sub_u32 s28, s28, 1
    s_cbranch_scc1 Lxdone_26
    s_waitcnt vmcnt(0)
    v_xor_b32 v2, s8, v2
    v_xor_b32 v3, s9, v3
    v_lshl_or_b32 v2, v3, 4, v2
    v_cmp_ne_u32 vcc, 0, v2
    s_nop 4
    s_cbranch_vccnz Lxpoll_27
    v_readfirstlane_b32 s30, v3
    s_nop 1
    v_cmp_ne_u32 vcc, s30, v3
    s_nop 0
    s_cmp_eq_u64 vcc, 0
    s_cselect_b32 s3, 1, 0
    s_nop 1
Lxdone_26:
    s_waitcnt vmcnt(0)
Lnox_24:
    s_waitcnt vmcnt(0)
    s_mul_i32 s35, s21, 6144
    s_add_u32 s35, s35, 64512
    v_add_u32 v20, s35, v4
    v_add_u32 v21, 49152, v20
    s_nop 4
Llwait_16:
    s_barrier
    ds_write_b128 v20, v[32:35] offset:0
    ds_write_b128 v20, v[36:39] offset:1024
    ds_write_b128 v20, v[40:43] offset:2048
    ds_write_b128 v20, v[44:47] offset:3072
    ds_write_b128 v20, v[48:51] offset:4096
    ds_write_b128 v20, v[52:55] offset:5120
    ds_write_b128 v20, v[56:59] offset:24576
    ds_write_b128 v20, v[60:63] offset:25600
    ds_write_b128 v20, v[64:67] offset:26624
    ds_write_b128 v20, v[68:71] offset:27648
    ds_write_b128 v20, v[72:75] offset:28672
    ds_write_b128 v20, v[76:79] offset:29696
    ds_write_b128 v21, v[80:83] offset:0
    ds_write_b128 v21, v[84:87] offset:1024
    ds_write_b128 v21, v[88:91] offset:2048
    ds_write_b128 v21, v[92:95] offset:3072
    ds_write_b128 v21, v[96:99] offset:4096
    ds_write_b128 v21, v[100:103] offset:5120
    ds_write_b128 v21, v[104:107] offset:24576
    ds_write_b128 v21, v[108:111] offset:25600
    ds_write_b128 v21, v[112:115] offset:26624
    ds_write_b128 v21, v[116:119] offset:27648
    ds_write_b128 v21, v[120:123] offset:28672
    ds_write_b128 v21, v[124:127] offset:29696
    v_mov_b32 v2, 1
    v_mov_b32 v3, 162816
    s_mov_b64 exec, 1
    ds_add_u32 v3, v2 offset:64
    s_mov_b64 exec, -1
    s_branch mega_g0
    s_nop 0
Lcomp_11:
    s_lshl_b32 s33, s41, 10
    s_add_u32 s33, s33, s42
    buffer_load_dwordx4 v[84:87], v4, s[12:15], s33 offen offset:0 sc1
    buffer_load_dwordx4 v[88:91], v4, s[12:15], s33 offen offset:1024 sc1
    v_mov_b32 v92, 0
    v_mov_b32 v93, 0
    v_mov_b32 v94, 0
    v_mov_b32 v95, 0
    v_mov_b32 v96, 0
    v_mov_b32 v97, 0
    v_mov_b32 v98, 0
    v_mov_b32 v99, 0
    v_mov_b32 v100, 0
    v_mov_b32 v101, 0
    v_mov_b32 v102, 0
    v_mov_b32 v103, 0
    v_mov_b32 v104, 0
    v_mov_b32 v105, 0
    v_mov_b32 v106, 0
    v_mov_b32 v107, 0
    v_mov_b32 v108, 0
    v_mov_b32 v109, 0
    v_mov_b32 v110, 0
    v_mov_b32 v111, 0
    v_mov_b32 v112, 0
    v_mov_b32 v113, 0
    v_mov_b32 v114, 0
    v_mov_b32 v115, 0
    v_mov_b32 v116, 0
    v_mov_b32 v117, 0
    v_mov_b32 v118, 0
    v_mov_b32 v119, 0
    v_mov_b32 v120, 0
    v_mov_b32 v121, 0
    v_mov_b32 v122, 0
    v_mov_b32 v123, 0
    v_mov_b32 v80, 0
    v_mov_b32 v40, 0
    v_mov_b32 v81, 0
    v_mov_b32 v41, 0
    v_mov_b32 v82, 0
    v_mov_b32 v42, 0
    v_mov_b32 v83, 0
    v_mov_b32 v43, 0
    v_mov_b32 v16, v4
    v_and_b32 v3, 15, v1
    v_lshlrev_b32 v3, 4, v3
    v_lshl_add_u32 v3, v5, 8, v3
    v_and_b32 v2, 16, v1
    v_cmp_eq_u32 vcc, 0, v2
    v_mov_b32 v2, 131072
    v_mov_b32 v17, 65536
    v_mov_b32 v18, 8192
    v_cndmask_b32 v17, v2, v17, vcc
    v_cndmask_b32 v18, 0, v18, vcc
    v_add_u32 v17, v17, v3
    s_mov_b32 s25, 0
    s_mov_b32 s27, 0x3
    s_waitcnt vmcnt(0) lgkmcnt(0)
    s_setprio 3
    s_barrier
    ds_read_b128 v[20:23], v16
    ds_read_b128 v[24:27], v16 offset:1024
    ds_read_b128 v[28:31], v17
    ds_read_b128 v[32:35], v17 offset:512
    s_waitcnt lgkmcnt(0)
    v_mfma_f32_32x32x16_bf16 v[44:59], v[20:23], v[84:87], 0
    s_nop 11
Lloop_28:
    v_mfma_f32_32x32x16_bf16 v[60:75], v[20:23], v[88:91], 0
    v_exp_f32 v44, v44
    v_exp_f32 v45, v45
    v_exp_f32 v46, v46
    v_exp_f32 v47, v47
    v_mfma_f32_32x32x16_bf16 v[108:123], v[40:43], v[80:83], v[108:123]
    ds_read_b128 v[36:39], v17 offset:1024
    ds_read_b128 v[40:43], v17 offset:1536
    v_exp_f32 v48, v48
    v_cvt_pk_bf16_f32 v76, v44, v45
    v_exp_f32 v49, v49
    v_exp_f32 v50, v50
    v_cvt_pk_bf16_f32 v77, v46, v47
    v_exp_f32 v51, v51
    v_exp_f32 v52, v52
    v_cvt_pk_bf16_f32 v78, v48, v49
    v_exp_f32 v53, v53
    v_exp_f32 v54, v54
    v_cvt_pk_bf16_f32 v79, v50, v51
    v_exp_f32 v55, v55
    v_exp_f32 v56, v56
    v_mfma_f32_32x32x16_bf16 v[92:107], v[28:31], v[76:79], v[92:107]
    v_cvt_pk_bf16_f32 v80, v52, v53
    v_exp_f32 v57, v57
    v_exp_f32 v58, v58
    v_exp_f32 v59, v59
    v_cvt_pk_bf16_f32 v81, v54, v55
    v_cvt_pk_bf16_f32 v82, v56, v57
    v_cvt_pk_bf16_f32 v83, v58, v59
    s_waitcnt lgkmcnt(0)
    v_mfma_f32_32x32x16_bf16 v[44:59], v[24:27], v[84:87], 0
    ds_read_b128 v[20:23], v16 offset:2048
    v_exp_f32 v60, v60
    v_exp_f32 v61, v61
    v_exp_f32 v62, v62
    v_exp_f32 v63, v63
    v_mfma_f32_32x32x16_bf16 v[92:107], v[32:35], v[80:83], v[92:107]
    v_exp_f32 v64, v64
    v_cvt_pk_bf16_f32 v76, v60, v61
    v_exp_f32 v65, v65
    v_exp_f32 v66, v66
    v_cvt_pk_bf16_f32 v77, v62, v63
    v_exp_f32 v67, v67
    v_exp_f32 v68, v68
    v_cvt_pk_bf16_f32 v78, v64, v65
    v_exp_f32 v69, v69
    v_exp_f32 v70, v70
    v_cvt_pk_bf16_f32 v79, v66, v67
    v_exp_f32 v71, v71
    v_exp_f32 v72, v72
    v_mfma_f32_32x32x16_bf16 v[108:123], v[28:31], v[76:79], v[108:123]
    v_cvt_pk_bf16_f32 v80, v68, v69
    v_exp_f32 v73, v73
    v_exp_f32 v74, v74
    v_exp_f32 v75, v75
    v_cvt_pk_bf16_f32 v81, v70, v71
    v_cvt_pk_bf16_f32 v82, v72, v73
    v_cvt_pk_bf16_f32 v83, v74, v75
    v_mfma_f32_32x32x16_bf16 v[60:75], v[24:27], v[88:91], 0
    v_exp_f32 v44, v44
    v_exp_f32 v45, v45
    v_exp_f32 v46, v46
    v_exp_f32 v47, v47
    v_mfma_f32_32x32x16_bf16 v[108:123], v[32:35], v[80:83], v[108:123]
    ds_read_b128 v[28:31], v17 offset:2048
    ds_read_b128 v[32:35], v17 offset:2560
    v_exp_f32 v48, v48
    v_cvt_pk_bf16_f32 v76, v44, v45
    v_exp_f32 v49, v49
    v_exp_f32 v50, v50
    v_cvt_pk_bf16_f32 v77, v46, v47
    v_exp_f32 v51, v51
    v_exp_f32 v52, v52
    v_cvt_pk_bf16_f32 v78, v48, v49
    v_exp_f32 v53, v53
    v_exp_f32 v54, v54
    v_cvt_pk_bf16_f32 v79, v50, v51
    v_exp_f32 v55, v55
    v_exp_f32 v56, v56
    v_mfma_f32_32x32x16_bf16 v[92:107], v[36:39], v[76:79], v[92:107]
    v_cvt_pk_bf16_f32 v80, v52, v53
    v_exp_f32 v57, v57
    v_exp_f32 v58, v58
    v_exp_f32 v59, v59
    v_cvt_pk_bf16_f32 v81, v54, v55
    v_cvt_pk_bf16_f32 v82, v56, v57
    v_cvt_pk_bf16_f32 v83, v58, v59
    s_waitcnt lgkmcnt(0)
    v_mfma_f32_32x32x16_bf16 v[44:59], v[20:23], v[84:87], 0
    ds_read_b128 v[24:27], v16 offset:3072
    v_exp_f32 v60, v60
    v_exp_f32 v61, v61
    v_exp_f32 v62, v62
    v_exp_f32 v63, v63
    v_mfma_f32_32x32x16_bf16 v[92:107], v[40:43], v[80:83], v[92:107]
    v_exp_f32 v64, v64
    v_cvt_pk_bf16_f32 v76, v60, v61
    v_exp_f32 v65, v65
    v_exp_f32 v66, v66
    v_cvt_pk_bf16_f32 v77, v62, v63
    v_exp_f32 v67, v67
    v_exp_f32 v68, v68
    v_cvt_pk_bf16_f32 v78, v64, v65
    v_exp_f32 v69, v69
    v_exp_f32 v70, v70
    v_cvt_pk_bf16_f32 v79, v66, v67
    v_exp_f32 v71, v71
    v_exp_f32 v72, v72
    v_mfma_f32_32x32x16_bf16 v[108:123], v[36:39], v[76:79], v[108:123]
    v_cvt_pk_bf16_f32 v80, v68, v69
    v_exp_f32 v73, v73
    v_exp_f32 v74, v74
    v_exp_f32 v75, v75
    v_cvt_pk_bf16_f32 v81, v70, v71
    v_cvt_pk_bf16_f32 v82, v72, v73
    v_cvt_pk_bf16_f32 v83, v74, v75
    v_mfma_f32_32x32x16_bf16 v[60:75], v[20:23], v[88:91], 0
    v_exp_f32 v44, v44
    v_exp_f32 v45, v45
    v_exp_f32 v46, v46
    v_exp_f32 v47, v47
    v_mfma_f32_32x32x16_bf16 v[108:123], v[40:43], v[80:83], v[108:123]
    ds_read_b128 v[36:39], v17 offset:3072
    ds_read_b128 v[40:43], v17 offset:3584
    v_exp_f32 v48, v48
    v_cvt_pk_bf16_f32 v76, v44, v45
    v_exp_f32 v49, v49
    v_exp_f32 v50, v50
    v_cvt_pk_bf16_f32 v77, v46, v47
    v_exp_f32 v51, v51
    v_exp_f32 v52, v52
    v_cvt_pk_bf16_f32 v78, v48, v49
    v_exp_f32 v53, v53
    v_exp_f32 v54, v54
    v_cvt_pk_bf16_f32 v79, v50, v51
    v_exp_f32 v55, v55
    v_exp_f32 v56, v56
    v_mfma_f32_32x32x16_bf16 v[92:107], v[28:31], v[76:79], v[92:107]
    v_cvt_pk_bf16_f32 v80, v52, v53
    v_exp_f32 v57, v57
    v_exp_f32 v58, v58
    v_exp_f32 v59, v59
    v_cvt_pk_bf16_f32 v81, v54, v55
    v_cvt_pk_bf16_f32 v82, v56, v57
    v_cvt_pk_bf16_f32 v83, v58, v59
    s_waitcnt lgkmcnt(0)
    v_mfma_f32_32x32x16_bf16 v[44:59], v[24:27], v[84:87], 0
    ds_read_b128 v[20:23], v16 offset:4096
    v_exp_f32 v60, v60
    v_exp_f32 v61, v61
    v_exp_f32 v62, v62
    v_exp_f32 v63, v63
    v_mfma_f32_32x32x16_bf16 v[92:107], v[32:35], v[80:83], v[92:107]
    v_exp_f32 v64, v64
    v_cvt_pk_bf16_f32 v76, v60, v61
    v_exp_f32 v65, v65
    v_exp_f32 v66, v66
    v_cvt_pk_bf16_f32 v77, v62, v63
    v_exp_f32 v67, v67
    v_exp_f32 v68, v68
    v_cvt_pk_bf16_f32 v78, v64, v65
    v_exp_f32 v69, v69
    v_exp_f32 v70, v70
    v_cvt_pk_bf16_f32 v79, v66, v67
    v_exp_f32 v71, v71
    v_exp_f32 v72, v72
    v_mfma_f32_32x32x16_bf16 v[108:123], v[28:31], v[76:79], v[108:123]
    v_cvt_pk_bf16_f32 v80, v68, v69
    v_exp_f32 v73, v73
    v_exp_f32 v74, v74
    v_exp_f32 v75, v75
    v_cvt_pk_bf16_f32 v81, v70, v71
    v_cvt_pk_bf16_f32 v82, v72, v73
    v_cvt_pk_bf16_f32 v83, v74, v75
    v_mfma_f32_32x32x16_bf16 v[60:75], v[24:27], v[88:91], 0
    v_exp_f32 v44, v44
    v_exp_f32 v45, v45
    v_exp_f32 v46, v46
    v_exp_f32 v47, v47
    v_mfma_f32_32x32x16_bf16 v[108:123], v[32:35], v[80:83], v[108:123]
    ds_read_b128 v[28:31], v17 offset:4096
    ds_read_b128 v[32:35], v17 offset:4608
    v_exp_f32 v48, v48
    v_cvt_pk_bf16_f32 v76, v44, v45
    v_exp_f32 v49, v49
    v_exp_f32 v50, v50
    v_cvt_pk_bf16_f32 v77, v46, v47
    v_exp_f32 v51, v51
    v_exp_f32 v52, v52
    v_cvt_pk_bf16_f32 v78, v48, v49
    v_exp_f32 v53, v53
    v_exp_f32 v54, v54
    v_cvt_pk_bf16_f32 v79, v50, v51
    v_exp_f32 v55, v55
    v_exp_f32 v56, v56
    v_mfma_f32_32x32x16_bf16 v[92:107], v[36:39], v[76:79], v[92:107]
    v_cvt_pk_bf16_f32 v80, v52, v53
    v_exp_f32 v57, v57
    v_exp_f32 v58, v58
    v_exp_f32 v59, v59
    v_cvt_pk_bf16_f32 v81, v54, v55
    v_cvt_pk_bf16_f32 v82, v56, v57
    v_cvt_pk_bf16_f32 v83, v58, v59
    s_waitcnt lgkmcnt(0)
    v_mfma_f32_32x32x16_bf16 v[44:59], v[20:23], v[84:87], 0
    ds_read_b128 v[24:27], v16 offset:5120
    v_exp_f32 v60, v60
    v_exp_f32 v61, v61
    v_exp_f32 v62, v62
    v_exp_f32 v63, v63
    v_mfma_f32_32x32x16_bf16 v[92:107], v[40:43], v[80:83], v[92:107]
    v_exp_f32 v64, v64
    v_cvt_pk_bf16_f32 v76, v60, v61
    v_exp_f32 v65, v65
    v_exp_f32 v66, v66
    v_cvt_pk_bf16_f32 v77, v62, v63
    v_exp_f32 v67, v67
    v_exp_f32 v68, v68
    v_cvt_pk_bf16_f32 v78, v64, v65
    v_exp_f32 v69, v69
    v_exp_f32 v70, v70
    v_cvt_pk_bf16_f32 v79, v66, v67
    v_exp_f32 v71, v71
    v_exp_f32 v72, v72
    v_mfma_f32_32x32x16_bf16 v[108:123], v[36:39], v[76:79], v[108:123]
    v_cvt_pk_bf16_f32 v80, v68, v69
    v_exp_f32 v73, v73
    v_exp_f32 v74, v74
    v_exp_f32 v75, v75
    v_cvt_pk_bf16_f32 v81, v70, v71
    v_cvt_pk_bf16_f32 v82, v72, v73
    v_cvt_pk_bf16_f32 v83, v74, v75
    v_mfma_f32_32x32x16_bf16 v[60:75], v[20:23], v[88:91], 0
    v_exp_f32 v44, v44
    v_exp_f32 v45, v45
    v_exp_f32 v46, v46
    v_exp_f32 v47, v47
    v_mfma_f32_32x32x16_bf16 v[108:123], v[40:43], v[80:83], v[108:123]
    ds_read_b128 v[36:39], v17 offset:5120
    ds_read_b128 v[40:43], v17 offset:5632
    v_exp_f32 v48, v48
    v_cvt_pk_bf16_f32 v76, v44, v45
    v_exp_f32 v49, v49
    v_exp_f32 v50, v50
    v_cvt_pk_bf16_f32 v77, v46, v47
    v_exp_f32 v51, v51
    v_exp_f32 v52, v52
    v_cvt_pk_bf16_f32 v78, v48, v49
    v_exp_f32 v53, v53
    v_exp_f32 v54, v54
    v_cvt_pk_bf16_f32 v79, v50, v51
    v_exp_f32 v55, v55
    v_exp_f32 v56, v56
    v_mfma_f32_32x32x16_bf16 v[92:107], v[28:31], v[76:79], v[92:107]
    v_cvt_pk_bf16_f32 v80, v52, v53
    v_exp_f32 v57, v57
    v_exp_f32 v58, v58
    v_exp_f32 v59, v59
    v_cvt_pk_bf16_f32 v81, v54, v55
    v_cvt_pk_bf16_f32 v82, v56, v57
    v_cvt_pk_bf16_f32 v83, v58, v59
    s_waitcnt lgkmcnt(0)
    v_mfma_f32_32x32x16_bf16 v[44:59], v[24:27], v[84:87], 0
    ds_read_b128 v[20:23], v16 offset:6144
    v_exp_f32 v60, v60
    v_exp_f32 v61, v61
    v_exp_f32 v62, v62
    v_exp_f32 v63, v63
    v_mfma_f32_32x32x16_bf16 v[92:107], v[32:35], v[80:83], v[92:107]
    v_exp_f32 v64, v64
    v_cvt_pk_bf16_f32 v76, v60, v61
    v_exp_f32 v65, v65
    v_exp_f32 v66, v66
    v_cvt_pk_bf16_f32 v77, v62, v63
    v_exp_f32 v67, v67
    v_exp_f32 v68, v68
    v_cvt_pk_bf16_f32 v78, v64, v65
    v_exp_f32 v69, v69
    v_exp_f32 v70, v70
    v_cvt_pk_bf16_f32 v79, v66, v67
    v_exp_f32 v71, v71
    v_exp_f32 v72, v72
    v_mfma_f32_32x32x16_bf16 v[108:123], v[28:31], v[76:79], v[108:123]
    v_cvt_pk_bf16_f32 v80, v68, v69
    v_exp_f32 v73, v73
    v_exp_f32 v74, v74
    v_exp_f32 v75, v75
    v_cvt_pk_bf16_f32 v81, v70, v71
    v_cvt_pk_bf16_f32 v82, v72, v73
    v_cvt_pk_bf16_f32 v83, v74, v75
    v_mfma_f32_32x32x16_bf16 v[60:75], v[24:27], v[88:91], 0
    v_exp_f32 v44, v44
    v_exp_f32 v45, v45
    v_exp_f32 v46, v46
    v_exp_f32 v47, v47
    v_mfma_f32_32x32x16_bf16 v[108:123], v[32:35], v[80:83], v[108:123]
    ds_read_b128 v[28:31], v17 offset:6144
    ds_read_b128 v[32:35], v17 offset:6656
    v_exp_f32 v48, v48
    v_cvt_pk_bf16_f32 v76, v44, v45
    v_exp_f32 v49, v49
    v_exp_f32 v50, v50
    v_cvt_pk_bf16_f32 v77, v46, v47
    v_exp_f32 v51, v51
    v_exp_f32 v52, v52
    v_cvt_pk_bf16_f32 v78, v48, v49
    v_exp_f32 v53, v53
    v_exp_f32 v54, v54
    v_cvt_pk_bf16_f32 v79, v50, v51
    v_exp_f32 v55, v55
    v_exp_f32 v56, v56
    v_mfma_f32_32x32x16_bf16 v[92:107], v[36:39], v[76:79], v[92:107]
    v_cvt_pk_bf16_f32 v80, v52, v53
    v_exp_f32 v57, v57
    v_exp_f32 v58, v58
    v_exp_f32 v59, v59
    v_cvt_pk_bf16_f32 v81, v54, v55
    v_cvt_pk_bf16_f32 v82, v56, v57
    v_cvt_pk_bf16_f32 v83, v58, v59
    s_waitcnt lgkmcnt(0)
    v_mfma_f32_32x32x16_bf16 v[44:59], v[20:23], v[84:87], 0
    ds_read_b128 v[24:27], v16 offset:7168
    v_exp_f32 v60, v60
    v_exp_f32 v61, v61
    v_exp_f32 v62, v62
    v_exp_f32 v63, v63
    v_mfma_f32_32x32x16_bf16 v[92:107], v[40:43], v[80:83], v[92:107]
    v_exp_f32 v64, v64
    v_cvt_pk_bf16_f32 v76, v60, v61
    v_exp_f32 v65, v65
    v_exp_f32 v66, v66
    v_cvt_pk_bf16_f32 v77, v62, v63
    v_exp_f32 v67, v67
    v_exp_f32 v68, v68
    v_cvt_pk_bf16_f32 v78, v64, v65
    v_exp_f32 v69, v69
    v_exp_f32 v70, v70
    v_cvt_pk_bf16_f32 v79, v66, v67
    v_exp_f32 v71, v71
    v_exp_f32 v72, v72
    v_mfma_f32_32x32x16_bf16 v[108:123], v[36:39], v[76:79], v[108:123]
    v_cvt_pk_bf16_f32 v80, v68, v69
    v_exp_f32 v73, v73
    v_exp_f32 v74, v74
    v_exp_f32 v75, v75
    v_cvt_pk_bf16_f32 v81, v70, v71
    v_cvt_pk_bf16_f32 v82, v72, v73
    v_cvt_pk_bf16_f32 v83, v74, v75
    v_mfma_f32_32x32x16_bf16 v[60:75], v[20:23], v[88:91], 0
    v_exp_f32 v44, v44
    v_exp_f32 v45, v45
    v_exp_f32 v46, v46
    v_exp_f32 v47, v47
    v_mfma_f32_32x32x16_bf16 v[108:123], v[40:43], v[80:83], v[108:123]
    ds_read_b128 v[36:39], v17 offset:7168
    ds_read_b128 v[40:43], v17 offset:7680
    v_exp_f32 v48, v48
    v_cvt_pk_bf16_f32 v76, v44, v45
    v_exp_f32 v49, v49
    v_exp_f32 v50, v50
    v_cvt_pk_bf16_f32 v77, v46, v47
    v_exp_f32 v51, v51
    v_exp_f32 v52, v52
    v_cvt_pk_bf16_f32 v78, v48, v49
    v_exp_f32 v53, v53
    v_exp_f32 v54, v54
    v_cvt_pk_bf16_f32 v79, v50, v51
    v_exp_f32 v55, v55
    v_exp_f32 v56, v56
    v_mfma_f32_32x32x16_bf16 v[92:107], v[28:31], v[76:79], v[92:107]
    v_cvt_pk_bf16_f32 v80, v52, v53
    v_exp_f32 v57, v57
    v_exp_f32 v58, v58
    v_exp_f32 v59, v59
    v_cvt_pk_bf16_f32 v81, v54, v55
    v_cvt_pk_bf16_f32 v82, v56, v57
    v_cvt_pk_bf16_f32 v83, v58, v59
    s_waitcnt lgkmcnt(0)
    v_mfma_f32_32x32x16_bf16 v[44:59], v[24:27], v[84:87], 0
    s_bitcmp1_b32 s27, s25
    s_cbranch_scc1 Lnb_29_b
Lnb_29:
    ds_read_b128 v[20:23], v16 offset:8192
    v_exp_f32 v60, v60
    v_exp_f32 v61, v61
    v_exp_f32 v62, v62
    v_exp_f32 v63, v63
    v_mfma_f32_32x32x16_bf16 v[92:107], v[32:35], v[80:83], v[92:107]
    v_exp_f32 v64, v64
    v_cvt_pk_bf16_f32 v76, v60, v61
    v_exp_f32 v65, v65
    v_exp_f32 v66, v66
    v_cvt_pk_bf16_f32 v77, v62, v63
    v_exp_f32 v67, v67
    v_exp_f32 v68, v68
    v_cvt_pk_bf16_f32 v78, v64, v65
    v_exp_f32 v69, v69
    v_exp_f32 v70, v70
    v_cvt_pk_bf16_f32 v79, v66, v67
    v_exp_f32 v71, v71
    v_exp_f32 v72, v72
    v_mfma_f32_32x32x16_bf16 v[108:123], v[28:31], v[76:79], v[108:123]
    v_cvt_pk_bf16_f32 v80, v68, v69
    v_exp_f32 v73, v73
    v_exp_f32 v74, v74
    v_exp_f32 v75, v75
    v_cvt_pk_bf16_f32 v81, v70, v71
    v_cvt_pk_bf16_f32 v82, v72, v73
    v_cvt_pk_bf16_f32 v83, v74, v75
    v_mfma_f32_32x32x16_bf16 v[60:75], v[24:27], v[88:91], 0
    v_exp_f32 v44, v44
    v_exp_f32 v45, v45
    v_exp_f32 v46, v46
    v_exp_f32 v47, v47
    v_mfma_f32_32x32x16_bf16 v[108:123], v[32:35], v[80:83], v[108:123]
    ds_read_b128 v[28:31], v17 offset:8192
    ds_read_b128 v[32:35], v17 offset:8704
    v_exp_f32 v48, v48
    v_cvt_pk_bf16_f32 v76, v44, v45
    v_exp_f32 v49, v49
    v_exp_f32 v50, v50
    v_cvt_pk_bf16_f32 v77, v46, v47
    v_exp_f32 v51, v51
    v_exp_f32 v52, v52
    v_cvt_pk_bf16_f32 v78, v48, v49
    v_exp_f32 v53, v53
    v_exp_f32 v54, v54
    v_cvt_pk_bf16_f32 v79, v50, v51
    v_exp_f32 v55, v55
    v_exp_f32 v56, v56
    v_mfma_f32_32x32x16_bf16 v[92:107], v[36:39], v[76:79], v[92:107]
    v_cvt_pk_bf16_f32 v80, v52, v53
    v_exp_f32 v57, v57
    v_exp_f32 v58, v58
    v_exp_f32 v59, v59
    v_cvt_pk_bf16_f32 v81, v54, v55
    v_cvt_pk_bf16_f32 v82, v56, v57
    v_cvt_pk_bf16_f32 v83, v58, v59
    s_waitcnt lgkmcnt(0)
    v_mfma_f32_32x32x16_bf16 v[44:59], v[20:23], v[84:87], 0
    ds_read_b128 v[24:27], v16 offset:9216
    v_exp_f32 v60, v60
    v_exp_f32 v61, v61
    v_exp_f32 v62, v62
    v_exp_f32 v63, v63
    v_mfma_f32_32x32x16_bf16 v[92:107], v[40:43], v[80:83], v[92:107]
    v_exp_f32 v64, v64
    v_cvt_pk_bf16_f32 v76, v60, v61
    v_exp_f32 v65, v65
    v_exp_f32 v66, v66
    v_cvt_pk_bf16_f32 v77, v62, v63
    v_exp_f32 v67, v67
    v_exp_f32 v68, v68
    v_cvt_pk_bf16_f32 v78, v64, v65
    v_exp_f32 v69, v69
    v_exp_f32 v70, v70
    v_cvt_pk_bf16_f32 v79, v66, v67
    v_exp_f32 v71, v71
    v_exp_f32 v72, v72
    v_mfma_f32_32x32x16_bf16 v[108:123], v[36:39], v[76:79], v[108:123]
    v_cvt_pk_bf16_f32 v80, v68, v69
    v_exp_f32 v73, v73
    v_exp_f32 v74, v74
    v_exp_f32 v75, v75
    v_cvt_pk_bf16_f32 v81, v70, v71
    v_add_u32 v16, 8192, v16
    v_add_u32 v17, v18, v17
    s_add_u32 s25, s25, 1
    s_cmp_lt_u32 s25, 8
    v_cvt_pk_bf16_f32 v82, v72, v73
    v_cvt_pk_bf16_f32 v83, v74, v75
    s_cbranch_scc1 Lloop_28
    s_nop 0
    v_mfma_f32_32x32x16_bf16 v[108:123], v[40:43], v[80:83], v[108:123]
Ltail_12:
    s_setprio 0
    v_mov_b32 v7, 162816
    ds_read_b32 v3, v7
    s_mov_b32 s30, 0x30800000
    s_mov_b32 s31, 0x58800000
    s_movk_i32 s32, 0x1f8
    s_mov_b64 s[34:35], -1
    s_lshl_b32 s36, s41, 15
    s_lshl_b32 s37, s40, 10
    s_add_u32 s36, s36, s37
    s_add_u32 s36, s36, s22
    s_add_u32 s36, s36, 0x600000
    s_add_u32 s37, s36, 32768
    s_waitcnt lgkmcnt(0)
    v_readfirstlane_b32 s3, v3
    v_rcp_f32 v2, v100
    v_cmp_le_f32 vcc, s30, v100
    v_mul_f32 v60, v2, v92
    v_mul_f32 v61, v2, v93
    v_mul_f32 v62, v2, v94
    v_mul_f32 v63, v2, v95
    v_mul_f32 v64, v2, v96
    v_mul_f32 v65, v2, v97
    v_mul_f32 v66, v2, v98
    v_mul_f32 v67, v2, v99
    s_and_b64 s[34:35], s[34:35], vcc
    v_cvt_pk_bf16_f32 v20, v60, v61
    v_cvt_pk_bf16_f32 v21, v62, v63
    v_cvt_pk_bf16_f32 v22, v64, v65
    v_cvt_pk_bf16_f32 v23, v66, v67
    v_cmp_ge_f32 vcc, s31, v100
    buffer_store_dwordx4 v[20:23], v4, s[12:15], s36 offen sc1
    s_and_b64 s[34:35], s[34:35], vcc
    v_rcp_f32 v2, v116
    v_cmp_le_f32 vcc, s30, v116
    v_mul_f32 v68, v2, v108
    v_mul_f32 v69, v2, v109
    v_mul_f32 v70, v2, v110
    v_mul_f32 v71, v2, v111
    v_mul_f32 v72, v2, v112
    v_mul_f32 v73, v2, v113
    v_mul_f32 v74, v2, v114
    v_mul_f32 v75, v2, v115
    s_and_b64 s[34:35], s[34:35], vcc
    v_cvt_pk_bf16_f32 v24, v68, v69
    v_cvt_pk_bf16_f32 v25, v70, v71
    v_cvt_pk_bf16_f32 v26, v72, v73
    v_cvt_pk_bf16_f32 v27, v74, v75
    v_cmp_ge_f32 vcc, s31, v116
    buffer_store_dwordx4 v[24:27], v4, s[12:15], s37 offen sc1
    s_and_b64 s[34:35], s[34:35], vcc
    v_add_f32 v60, v60, v68
    v_add_f32 v61, v61, v69
    v_add_f32 v62, v62, v70
    v_add_f32 v63, v63, v71
    v_add_f32 v64, v64, v72
    v_add_f32 v65, v65, v73
    v_add_f32 v66, v66, v74
    v_add_f32 v67, v67, v75
    v_add_f32 v60, v60, v64
    v_add_f32 v61, v61, v65
    v_add_f32 v62, v62, v66
    v_add_f32 v63, v63, v67
    v_add_f32 v60, v60, v62
    v_add_f32 v61, v61, v63
    v_add_f32 v60, v60, v61
    v_cmp_class_f32 vcc, v60, s32
    s_lshr_b32 s30, s41, 1
    s_lshl_b32 s30, s30, 9
    s_lshl_b32 s31, s40, 3
    s_add_u32 s30, s30, s31
    s_add_u32 s30, s30, s22
    s_add_u32 s30, s30, 0x1308000
    s_and_b64 s[34:35], s[34:35], vcc
    s_cmp_lg_u64 s[34:35], -1
    s_cselect_b32 s31, 1, 0
    s_cmp_gt_u32 s31, s26
    s_cbranch_scc1 Lslow_13
    s_barrier
    v_mov_b32 v2, s8
    v_mov_b32 v3, s9
    v_mov_b32 v7, 0
    s_mov_b64 exec, 1
    s_waitcnt vmcnt(0)
    buffer_store_dwordx2 v[2:3], v7, s[12:15], s30 offen sc1
    s_mov_b64 exec, -1
    s_nop 0
mega_g1:
    v_lshrrev_b32 v2, 3, v1
    v_bfe_u32 v3, v1, 4, 1
    v_lshlrev_b32 v3, 2, v3
    v_and_b32 v16, 7, v1
    v_xor_b32 v16, v16, v3
    v_lshlrev_b32 v16, 4, v16
    v_lshl_add_u32 v16, v2, 10, v16
    s_lshr_b32 s30, s24, 2
    s_lshl_b32 s30, s30, 7
    s_lshl_b32 s31, s21, 13
    s_add_u32 s30, s30, s31
    s_lshr_b32 s31, s21, 1
    s_and_b32 s32, s21, 1
    s_mul_i32 s31, s31, 22528
    s_lshl_b32 s32, s32, 10
    s_add_u32 s31, s31, s32
    s_add_u32 m0, s31, 16384
    s_add_u32 s33, s30, 0
    buffer_load_dwordx4 v16, s[52:55], s33 offen lds
    s_add_u32 m0, s31, 18432
    s_add_u32 s33, s30, 32768
    buffer_load_dwordx4 v16, s[52:55], s33 offen lds
    s_add_u32 m0, s31, 20480
    s_add_u32 s33, s30, 65536
    buffer_load_dwordx4 v16, s[52:55], s33 offen lds
    s_add_u32 m0, s31, 22528
    s_add_u32 s33, s30, 98304
    buffer_load_dwordx4 v16, s[52:55], s33 offen lds
    s_add_u32 m0, s31, 24576
    s_add_u32 s33, s30, 131072
    buffer_load_dwordx4 v16, s[52:55], s33 offen lds
    s_add_u32 m0, s31, 26624
    s_add_u32 s33, s30, 163840
    buffer_load_dwordx4 v16, s[52:55], s33 offen lds
    s_add_u32 m0, s31, 28672
    s_add_u32 s33, s30, 196608
    buffer_load_dwordx4 v16, s[52:55], s33 offen lds
    s_add_u32 m0, s31, 30720
    s_add_u32 s33, s30, 229376
    buffer_load_dwordx4 v16, s[52:55], s33 offen lds
    s_add_u32 m0, s31, 32768
    s_add_u32 s33, s30, 262144
    buffer_load_dwordx4 v16, s[52:55], s33 offen lds
    s_add_u32 m0, s31, 34816
    s_add_u32 s33, s30, 294912
    buffer_load_dwordx4 v16, s[52:55], s33 offen lds
    s_add_u32 m0, s31, 36864
    s_add_u32 s33, s30, 327680
    buffer_load_dwordx4 v16, s[52:55], s33 offen lds
    s_lshr_b32 s41, s24, 1
    s_lshl_b32 s42, s23, 2
    s_and_b32 s30, s24, 3
    s_add_u32 s42, s42, s30
    s_lshl_b32 s42, s42, 9
    s_add_u32 s42, s42, s22
    s_add_u32 s42, s42, 0x1308000
    s_cmp_eq_u32 s20, 4
    s_cbranch_scc1 Lpol_33
    s_add_u32 s29, s29, 1
Lrel_34:
    s_lshr_b32 s42, s92, 2
    s_lshl_b32 s42, s42, 9
    s_add_u32 s42, s42, s22
    s_add_u32 s42, s42, 0x1304000
    s_lshl_b32 s43, s23, 1
    s_bfe_u32 s30, s24, 0x10001
    s_add_u32 s43, s43, s30
    s_lshl_b32 s43, s43, 9
    s_add_u32 s43, s43, s22
    s_add_u32 s43, s43, 0x1306000
    s_cmp_lg_u32 s22, 0
    s_cbranch_scc1 Lnocs_36
    v_mov_b32 v3, 162816
Lgs_37:
    ds_read_b32 v2, v3 offset:64
    s_waitcnt lgkmcnt(0)
    v_cmp_gt_u32 vcc, s100, v2
    s_nop 4
    s_cbranch_vccnz Lgs_37
    v_and_b32 v7, 31, v1
    v_lshlrev_b32 v7, 1, v7
    s_mul_i32 s30, s41, 192
    s_cmp_eq_u32 s21, 3
    s_cselect_b32 s38, 0, -1
    buffer_load_ushort v32, v7, s[56:59], s30 offen offset:0
    buffer_load_ushort v33, v7, s[56:59], s30 offen offset:64
    buffer_load_ushort v34, v7, s[56:59], s30 offen offset:128
    v_bfe_u32 v2, v1, 2, 2
    v_lshl_add_u32 v2, v5, 2, v2
    v_mul_u32_u24 v2, 192, v2
    v_bfe_u32 v3, v1, 4, 1
    v_lshl_add_u32 v2, v3, 5, v2
    v_and_b32 v3, 3, v1
    v_lshl_add_u32 v24, v3, 3, v2
    s_mul_i32 s30, s21, 6144
    s_add_u32 s30, s30, 64512
    v_add_u32 v24, s30, v24
    v_add_u32 v25, 49152, v24
    v_mov_b32 v28, 0x3f803f80
    v_mov_b32 v29, 0x3f803f80
    v_mov_b32 v30, 0x3f803f80
    v_mov_b32 v31, 0x3f803f80
    ds_read_b64_tr_b16 v[36:37], v24 offset:0
    ds_read_b64_tr_b16 v[38:39], v24 offset:1536
    ds_read_b64_tr_b16 v[40:41], v24 offset:64
    ds_read_b64_tr_b16 v[42:43], v24 offset:1600
    ds_read_b64_tr_b16 v[44:45], v24 offset:128
    ds_read_b64_tr_b16 v[46:47], v24 offset:1664
    ds_read_b64_tr_b16 v[48:49], v24 offset:3072
    ds_read_b64_tr_b16 v[50:51], v24 offset:4608
    ds_read_b64_tr_b16 v[52:53], v24 offset:3136
    ds_read_b64_tr_b16 v[54:55], v24 offset:4672
    ds_read_b64_tr_b16 v[56:57], v24 offset:3200
    ds_read_b64_tr_b16 v[58:59], v24 offset:4736
    s_waitcnt lgkmcnt(6)
    v_mfma_f32_32x32x16_bf16 v[60:75], v[28:31], v[36:39], 0
    v_mfma_f32_32x32x16_bf16 v[76:91], v[28:31], v[40:43], 0
    v_mfma_f32_32x32x16_bf16 v[92:107], v[28:31], v[44:47], 0
    s_waitcnt lgkmcnt(0)
    v_mfma_f32_32x32x16_bf16 v[60:75], v[28:31], v[48:51], v[60:75]
    v_mfma_f32_32x32x16_bf16 v[76:91], v[28:31], v[52:55], v[76:91]
    v_mfma_f32_32x32x16_bf16 v[92:107], v[28:31], v[56:59], v[92:107]
    ds_read_b64_tr_b16 v[36:37], v24 offset:24576
    ds_read_b64_tr_b16 v[38:39], v24 offset:26112
    ds_read_b64_tr_b16 v[40:41], v24 offset:24640
    ds_read_b64_tr_b16 v[42:43], v24 offset:26176
    ds_read_b64_tr_b16 v[44:45], v24 offset:24704
    ds_read_b64_tr_b16 v[46:47], v24 offset:26240
    ds_read_b64_tr_b16 v[48:49], v24 offset:27648
    ds_read_b64_tr_b16 v[50:51], v24 offset:29184
    ds_read_b64_tr_b16 v[52:53], v24 offset:27712
    ds_read_b64_tr_b16 v[54:55], v24 offset:29248
    ds_read_b64_tr_b16 v[56:57], v24 offset:27776
    ds_read_b64_tr_b16 v[58:59], v24 offset:29312
    s_waitcnt lgkmcnt(6)
    v_mfma_f32_32x32x16_bf16 v[60:75], v[28:31], v[36:39], v[60:75]
    v_mfma_f32_32x32x16_bf16 v[76:91], v[28:31], v[40:43], v[76:91]
    v_mfma_f32_32x32x16_bf16 v[92:107], v[28:31], v[44:47], v[92:107]
    s_waitcnt lgkmcnt(0)
    v_mfma_f32_32x32x16_bf16 v[60:75], v[28:31], v[48:51], v[60:75]
    v_mfma_f32_32x32x16_bf16 v[76:91], v[28:31], v[52:55], v[76:91]
    v_mfma_f32_32x32x16_bf16 v[92:107], v[28:31], v[56:59], v[92:107]
    ds_read_b64_tr_b16 v[36:37], v25 offset:0
    ds_read_b64_tr_b16 v[38:39], v25 offset:1536
    ds_read_b64_tr_b16 v[40:41], v25 offset:64
    ds_read_b64_tr_b16 v[42:43], v25 offset:1600
    ds_read_b64_tr_b16 v[44:45], v25 offset:128
    ds_read_b64_tr_b16 v[46:47], v25 offset:1664
    ds_read_b64_tr_b16 v[48:49], v25 offset:3072
    ds_read_b64_tr_b16 v[50:51], v25 offset:4608
    ds_read_b64_tr_b16 v[52:53], v25 offset:3136
    ds_read_b64_tr_b16 v[54:55], v25 offset:4672
    ds_read_b64_tr_b16 v[56:57], v25 offset:3200
    ds_read_b64_tr_b16 v[58:59], v25 offset:4736
    s_waitcnt lgkmcnt(6)
    v_mfma_f32_32x32x16_bf16 v[60:75], v[28:31], v[36:39], v[60:75]
    v_mfma_f32_32x32x16_bf16 v[76:91], v[28:31], v[40:43], v[76:91]
    v_mfma_f32_32x32x16_bf16 v[92:107], v[28:31], v[44:47], v[92:107]
    s_waitcnt lgkmcnt(0)
    v_mfma_f32_32x32x16_bf16 v[60:75], v[28:31], v[48:51], v[60:75]
    v_mfma_f32_32x32x16_bf16 v[76:91], v[28:31], v[52:55], v[76:91]
    v_mfma_f32_32x32x16_bf16 v[92:107], v[28:31], v[56:59], v[92:107]
    ds_read_b64_tr_b16 v[36:37], v25 offset:24576
    ds_read_b64_tr_b16 v[38:39], v25 offset:26112
    ds_read_b64_tr_b16 v[40:41], v25 offset:24640
    ds_read_b64_tr_b16 v[42:43], v25 offset:26176
    ds_read_b64_tr_b16 v[44:45], v25 offset:24704
    ds_read_b64_tr_b16 v[46:47], v25 offset:26240
    ds_read_b64_tr_b16 v[48:49], v25 offset:27648
    ds_read_b64_tr_b16 v[50:51], v25 offset:29184
    ds_read_b64_tr_b16 v[52:53], v25 offset:27712
    ds_read_b64_tr_b16 v[54:55], v25 offset:29248
    ds_read_b64_tr_b16 v[56:57], v25 offset:27776
    ds_read_b64_tr_b16 v[58:59], v25 offset:29312
    s_waitcnt lgkmcnt(6)
    v_mfma_f32_32x32x16_bf16 v[60:75], v[28:31], v[36:39], v[60:75]
    v_mfma_f32_32x32x16_bf16 v[76:91], v[28:31], v[40:43], v[76:91]
    v_mfma_f32_32x32x16_bf16 v[92:107], v[28:31], v[44:47], v[92:107]
    s_waitcnt lgkmcnt(0)
    v_mfma_f32_32x32x16_bf16 v[60:75], v[28:31], v[48:51], v[60:75]
    v_mfma_f32_32x32x16_bf16 v[76:91], v[28:31], v[52:55], v[76:91]
    v_mfma_f32_32x32x16_bf16 v[92:107], v[28:31], v[56:59], v[92:107]
    s_waitcnt vmcnt(0)
    v_lshlrev_b32 v32, 16, v32
    v_and_b32 v32, s38, v32
    v_lshlrev_b32 v33, 16, v33
    v_and_b32 v33, s38, v33
    v_lshlrev_b32 v34, 16, v34
    v_and_b32 v34, s38, v34
    s_nop 2
    v_cvt_pk_bf16_f32 v8, v60, v60
    v_and_b32 v2, 0xffff0000, v8
    v_sub_f32 v2, v60, v2
    v_cvt_pk_bf16_f32 v9, v2, v32
    v_cvt_pk_bf16_f32 v10, v76, v76
    v_and_b32 v2, 0xffff0000, v10
    v_sub_f32 v2, v76, v2
    v_cvt_pk_bf16_f32 v11, v2, v33
    v_cvt_pk_bf16_f32 v12, v92, v92
    v_and_b32 v2, 0xffff0000, v12
    v_sub_f32 v2, v92, v2
    v_cvt_pk_bf16_f32 v13, v2, v34
    s_nop 4
Lnocs_36:
    v_and_b32 v2, 31, v1
    s_lshr_b32 s30, s21, 1
    s_lshl_b32 s30, s30, 9
    s_and_b32 s31, s21, 1
    s_lshl_b32 s31, s31, 3
    s_add_u32 s30, s30, s31
    s_add_u32 s30, s30, 61440
    v_lshl_add_u32 v2, v2, 4, s30
    ds_write_b64 v2, v[8:9] offset:0
    ds_write_b64 v2, v[10:11] offset:1024
    ds_write_b64 v2, v[12:13] offset:2048
    s_barrier
    s_cmp_eq_u32 s20, 4
    s_cbranch_scc1 Lpol_40
    s_add_u32 s29, s29, 1
Lrel_41:
    s_add_u32 s42, s42, 32768
    s_waitcnt vmcnt(0) lgkmcnt(0)
    s_barrier
    s_lshr_b32 s30, s24, 2
    s_lshl_b32 s30, s30, 7
    s_lshl_b32 s31, s21, 13
    s_add_u32 s30, s30, s31
    s_add_u32 s30, s30, 360448
    buffer_load_dwordx4 v[24:27], v16, s[52:55], s30 offen
    s_add_u32 s30, s30, 32768
    buffer_load_dwordx4 v[28:31], v16, s[52:55], s30 offen
    s_add_u32 s30, s30, 32768
    buffer_load_dwordx4 v[32:35], v16, s[52:55], s30 offen
    s_add_u32 s30, s30, 32768
    buffer_load_dwordx4 v[36:39], v16, s[52:55], s30 offen
    s_add_u32 s30, s30, 32768
    buffer_load_dwordx4 v[40:43], v16, s[52:55], s30 offen
    s_add_u32 s30, s30, 32768
    buffer_load_dwordx4 v[44:47], v16, s[52:55], s30 offen
    s_add_u32 s30, s30, 32768
    buffer_load_dwordx4 v[48:51], v16, s[52:55], s30 offen
    s_add_u32 s30, s30, 32768
    buffer_load_dwordx4 v[52:55], v16, s[52:55], s30 offen
    s_add_u32 s30, s30, 32768
    buffer_load_dwordx4 v[56:59], v16, s[52:55], s30 offen
    s_add_u32 s30, s30, 32768
    buffer_load_dwordx4 v[60:63], v16, s[52:55], s30 offen
    s_add_u32 s30, s30, 32768
    buffer_load_dwordx4 v[64:67], v16, s[52:55], s30 offen
    s_add_u32 s30, s30, 32768
    buffer_load_dwordx4 v[68:71], v16, s[52:55], s30 offen
    s_add_u32 s30, s30, 32768
    buffer_load_dwordx4 v[72:75], v16, s[52:55], s30 offen
    s_add_u32 s30, s30, 32768
    buffer_load_dwordx4 v[76:79], v16, s[52:55], s30 offen
    s_add_u32 s30, s30, 32768
    buffer_load_dwordx4 v[80:83], v16, s[52:55], s30 offen
    s_add_u32 s30, s30, 32768
    buffer_load_dwordx4 v[84:87], v16, s[52:55], s30 offen
    s_add_u32 s30, s30, 32768
    buffer_load_dwordx4 v[88:91], v16, s[52:55], s30 offen
    s_add_u32 s30, s30, 32768
    buffer_load_dwordx4 v[92:95], v16, s[52:55], s30 offen
    s_add_u32 s30, s30, 32768
    buffer_load_dwordx4 v[96:99], v16, s[52:55], s30 offen
    s_add_u32 s30, s30, 32768
    buffer_load_dwordx4 v[100:103], v16, s[52:55], s30 offen
    s_add_u32 s30, s30, 32768
    buffer_load_dwordx4 v[104:107], v16, s[52:55], s30 offen
    s_add_u32 s30, s30, 32768
    buffer_load_dwordx4 v[108:111], v16, s[52:55], s30 offen
    s_add_u32 s30, s30, 32768
    buffer_load_dwordx4 v[112:115], v16, s[52:55], s30 offen
    s_add_u32 s30, s30, 32768
    buffer_load_dwordx4 v[116:119], v16, s[52:55], s30 offen
    s_add_u32 s30, s30, 32768
    buffer_load_dwordx4 v[120:123], v16, s[52:55], s30 offen
    s_add_u32 s30, s30, 32768
    buffer_load_dwordx4 v[124:127], v16, s[52:55], s30 offen
    s_add_u32 s30, s30, 32768
    buffer_load_dwordx4 v[128:131], v16, s[52:55], s30 offen
    s_add_u32 s30, s30, 32768
    buffer_load_dwordx4 v[132:135], v16, s[52:55], s30 offen
    s_add_u32 s30, s30, 32768
    buffer_load_dwordx4 v[136:139], v16, s[52:55], s30 offen
    s_add_u32 s30, s30, 32768
    buffer_load_dwordx4 v[140:143], v16, s[52:55], s30 offen
    s_add_u32 s30, s30, 32768
    buffer_load_dwordx4 v[144:147], v16, s[52:55], s30 offen
    s_add_u32 s30, s30, 32768
    buffer_load_dwordx4 v[148:151], v16, s[52:55], s30 offen
    v_mov_b32 v3, 162816
Lgs_43:
    ds_read_b32 v2, v3 offset:36
    s_waitcnt lgkmcnt(0)
    v_cmp_gt_u32 vcc, s100, v2
    s_nop 4
    s_cbranch_vccnz Lgs_43
    s_waitcnt vmcnt(0)
    s_cmp_eq_u32 s20, 4
    s_cbranch_scc1 Lpol_46
    s_add_u32 s29, s29, 1
Lrel_47:
    s_lshr_b32 s31, s21, 1
    s_and_b32 s32, s21, 1
    s_mul_i32 s31, s31, 49152
    s_lshl_b32 s32, s32, 10
    s_add_u32 s31, s31, s32
    s_add_u32 s31, s31, 64512
    v_add_u32 v2, s31, v4
    ds_write_b128 v2, v[24:27] offset:0
    ds_write_b128 v2, v[28:31] offset:2048
    ds_write_b128 v2, v[32:35] offset:4096
    ds_write_b128 v2, v[36:39] offset:6144
    ds_write_b128 v2, v[40:43] offset:8192
    ds_write_b128 v2, v[44:47] offset:10240
    ds_write_b128 v2, v[48:51] offset:12288
    ds_write_b128 v2, v[52:55] offset:14336
    ds_write_b128 v2, v[56:59] offset:16384
    ds_write_b128 v2, v[60:63] offset:18432
    ds_write_b128 v2, v[64:67] offset:20480
    ds_write_b128 v2, v[68:71] offset:22528
    ds_write_b128 v2, v[72:75] offset:24576
    ds_write_b128 v2, v[76:79] offset:26624
    ds_write_b128 v2, v[80:83] offset:28672
    ds_write_b128 v2, v[84:87] offset:30720
    ds_write_b128 v2, v[88:91] offset:32768
    ds_write_b128 v2, v[92:95] offset:34816
    ds_write_b128 v2, v[96:99] offset:36864
    ds_write_b128 v2, v[100:103] offset:38912
    ds_write_b128 v2, v[104:107] offset:40960
    ds_write_b128 v2, v[108:111] offset:43008
    ds_write_b128 v2, v[112:115] offset:45056
    ds_write_b128 v2, v[116:119] offset:47104
    s_waitcnt lgkmcnt(0)
    s_barrier
    s_lshr_b32 s31, s21, 1
    s_and_b32 s32, s21, 1
    s_mul_i32 s31, s31, 22528
    s_lshl_b32 s32, s32, 10
    s_add_u32 s31, s31, s32
    s_add_u32 s31, s31, 16384
    v_add_u32 v2, s31, v4
    ds_write_b128 v2, v[120:123] offset:0
    ds_write_b128 v2, v[124:127] offset:2048
    ds_write_b128 v2, v[128:131] offset:4096
    ds_write_b128 v2, v[132:135] offset:6144
    ds_write_b128 v2, v[136:139] offset:8192
    ds_write_b128 v2, v[140:143] offset:10240
    ds_write_b128 v2, v[144:147] offset:12288
    ds_write_b128 v2, v[148:151] offset:14336
    s_add_u32 s30, s21, s23
    s_and_b32 s30, s30, 3
    s_mul_i32 s30, s30, 24576
    s_add_u32 s30, s30, 64512
    v_add_u32 v20, s30, v4
    s_min_u32 s30, s21, 2
    s_lshl_b32 s30, s30, 10
    v_add_u32 v21, s30, v4
    s_waitcnt lgkmcnt(0)
    s_barrier
    s_barrier
    s_cmp_lg_u32 s22, 0
    s_cbranch_scc1 mega_fin
    s_cmp_eq_u32 s20, 4
    s_cbranch_scc1 Lpol_51
    s_add_u32 s29, s29, 1
Lrel_52:
    ds_write_b128 v20, v[156:159] offset:0
    ds_write_b128 v20, v[160:163] offset:1024
    ds_write_b128 v20, v[164:167] offset:2048
    ds_write_b128 v20, v[168:171] offset:3072
    ds_write_b128 v20, v[172:175] offset:4096
    ds_write_b128 v20, v[176:179] offset:5120
    ds_write_b128 v20, v[180:183] offset:6144
    ds_write_b128 v20, v[184:187] offset:7168
    ds_write_b128 v20, v[188:191] offset:8192
    ds_write_b128 v20, v[192:195] offset:9216
    ds_write_b128 v20, v[196:199] offset:10240
    ds_write_b128 v20, v[200:203] offset:11264
    ds_write_b128 v20, v[204:207] offset:12288
    ds_write_b128 v20, v[208:211] offset:13312
    ds_write_b128 v20, v[212:215] offset:14336
    ds_write_b128 v20, v[216:219] offset:15360
    ds_write_b128 v20, v[220:223] offset:16384
    ds_write_b128 v20, v[224:227] offset:17408
    ds_write_b128 v20, v[228:231] offset:18432
    ds_write_b128 v20, v[232:235] offset:19456
    ds_write_b128 v20, v[236:239] offset:20480
    ds_write_b128 v20, v[240:243] offset:21504
    ds_write_b128 v20, v[244:247] offset:22528
    ds_write_b128 v20, v[248:251] offset:23552
    ds_write_b128 v21, v[252:255] offset:61440
    s_waitcnt lgkmcnt(0)
    s_barrier
    s_barrier
    v_mov_b32 v3, 162816
Lgs_54:
    ds_read_b32 v2, v3 offset:60
    s_waitcnt lgkmcnt(0)
    v_cmp_gt_u32 vcc, s100, v2
    s_nop 4
    s_cbranch_vccnz Lgs_54
    s_branch mega_next
mega_g0:
    s_setprio 2
    s_lshl_b32 s40, s23, 2
    s_and_b32 s41, s24, 3
    s_add_u32 s40, s40, s41
    s_lshl_b32 s40, s40, 1
    s_and_b32 s41, s21, 1
    s_add_u32 s40, s40, s41
    s_lshr_b32 s41, s24, 2
    s_lshr_b32 s42, s21, 1
    s_lshl_b32 s43, s41, 1
    s_add_u32 s43, s43, s42
    s_mul_i32 s36, s40, 32768
    s_mul_i32 s31, s42, 16384
    s_add_u32 s36, s36, s31
    s_add_u32 s36, s36, s22
    s_add_u32 s36, s36, 0x600000
    v_mov_b32 v3, 162824
    s_add_u32 s29, s29, 1
Loth_55:
    ds_read_b32 v2, v3
    s_waitcnt lgkmcnt(0)
    v_cmp_gt_u32 vcc, s29, v2
    s_nop 4
    s_cbranch_vccnz Loth_55
    buffer_load_dwordx4 v[56:59], v4, s[12:15], s36 offen offset:0 sc1
    v_lshlrev_b32 v20, 16, v8
    v_and_b32 v21, 0xffff0000, v8
    buffer_load_dwordx4 v[60:63], v4, s[12:15], s36 offen offset:1024 sc1
    v_lshlrev_b32 v22, 16, v9
    v_and_b32 v23, 0xffff0000, v9
    v_lshlrev_b32 v24, 16, v10
    buffer_load_dwordx4 v[64:67], v4, s[12:15], s36 offen offset:2048 sc1
    v_and_b32 v25, 0xffff0000, v10
    v_lshlrev_b32 v26, 16, v11
    v_and_b32 v27, 0xffff0000, v11
    buffer_load_dwordx4 v[68:71], v4, s[12:15], s36 offen offset:3072 sc1
    s_add_u32 s36, s36, 4096
    v_lshlrev_b32 v28, 16, v12
    v_and_b32 v29, 0xffff0000, v12
    buffer_load_dwordx4 v[72:75], v4, s[12:15], s36 offen offset:0 sc1
    v_lshlrev_b32 v30, 16, v13
    v_and_b32 v31, 0xffff0000, v13
    v_lshlrev_b32 v32, 16, v14
    buffer_load_dwordx4 v[76:79], v4, s[12:15], s36 offen offset:1024 sc1
    v_and_b32 v33, 0xffff0000, v14
    v_lshlrev_b32 v34, 16, v15
    v_and_b32 v35, 0xffff0000, v15
    buffer_load_dwordx4 v[80:83], v4, s[12:15], s36 offen offset:2048 sc1
    s_lshl_b32 s30, s40, 15
    s_lshl_b32 s31, s43, 11
    s_add_u32 s30, s30, s31
    s_add_u32 s30, s30, s22
    s_add_u32 s30, s30, 0x800000
    s_lshl_b32 s32, s40, 12
    s_lshr_b32 s31, s43, 2
    s_lshl_b32 s31, s31, 10
    s_add_u32 s32, s32, s31
    s_and_b32 s31, s43, 3
    s_lshl_b32 s31, s31, 2
    s_add_u32 s32, s32, s31
    buffer_load_dwordx4 v[84:87], v4, s[12:15], s36 offen offset:3072 sc1
    s_add_u32 s36, s36, 4096
    s_add_u32 s32, s32, s22
    s_add_u32 s32, s32, 0x1200000
    s_lshr_b32 s33, s40, 2
    s_lshl_b32 s33, s33, 9
    s_bfe_u32 s31, s40, 0x10001
    s_lshl_b32 s31, s31, 8
    s_add_u32 s33, s33, s31
    s_lshl_b32 s31, s21, 3
    s_add_u32 s33, s33, s31
    buffer_load_dwordx4 v[88:91], v4, s[12:15], s36 offen offset:0 sc1
    s_lshl_b32 s31, s41, 5
    s_add_u32 s33, s33, s31
    s_add_u32 s33, s33, s22
    s_add_u32 s33, s33, 0x1304000
    s_mov_b32 s34, 0x3f803f80
    s_xor_b32 s31, s21, 2
    s_lshl_b32 s31, s31, 12
    buffer_load_dwordx4 v[92:95], v4, s[12:15], s36 offen offset:1024 sc1
    v_add_u32 v2, s31, v4
    s_lshl_b32 s31, s21, 12
    v_add_u32 v3, s31, v4
    s_waitcnt vmcnt(9)
    v_mfma_f32_32x32x16_bf16 v[36:51], v[132:135], v[56:59], 0
    buffer_load_dwordx4 v[96:99], v4, s[12:15], s36 offen offset:2048 sc1
    v_mfma_f32_32x32x16_bf16 v[20:35], v[128:131], v[56:59], v[20:35]
    s_waitcnt vmcnt(9)
    v_mfma_f32_32x32x16_bf16 v[36:51], v[140:143], v[60:63], v[36:51]
    buffer_load_dwordx4 v[100:103], v4, s[12:15], s36 offen offset:3072 sc1
    s_add_u32 s36, s36, 4096
    v_mfma_f32_32x32x16_bf16 v[20:35], v[136:139], v[60:63], v[20:35]
    s_waitcnt vmcnt(9)
    v_mfma_f32_32x32x16_bf16 v[36:51], v[148:151], v[64:67], v[36:51]
    buffer_load_dwordx4 v[104:107], v4, s[12:15], s36 offen offset:0 sc1
    v_mfma_f32_32x32x16_bf16 v[20:35], v[144:147], v[64:67], v[20:35]
    s_waitcnt vmcnt(9)
    v_mfma_f32_32x32x16_bf16 v[36:51], v[156:159], v[68:71], v[36:51]
    buffer_load_dwordx4 v[108:111], v4, s[12:15], s36 offen offset:1024 sc1
    v_mfma_f32_32x32x16_bf16 v[20:35], v[152:155], v[68:71], v[20:35]
    s_waitcnt vmcnt(9)
    v_mfma_f32_32x32x16_bf16 v[36:51], v[164:167], v[72:75], v[36:51]
    buffer_load_dwordx4 v[112:115], v4, s[12:15], s36 offen offset:2048 sc1
    v_mfma_f32_32x32x16_bf16 v[20:35], v[160:163], v[72:75], v[20:35]
    s_waitcnt vmcnt(9)
    v_mfma_f32_32x32x16_bf16 v[36:51], v[172:175], v[76:79], v[36:51]
    buffer_load_dwordx4 v[116:119], v4, s[12:15], s36 offen offset:3072 sc1
    s_add_u32 s36, s36, 4096
    v_mfma_f32_32x32x16_bf16 v[20:35], v[168:171], v[76:79], v[20:35]
    s_waitcnt vmcnt(9)
    v_mfma_f32_32x32x16_bf16 v[36:51], v[180:183], v[80:83], v[36:51]
    v_mfma_f32_32x32x16_bf16 v[20:35], v[176:179], v[80:83], v[20:35]
    s_waitcnt vmcnt(8)
    v_mfma_f32_32x32x16_bf16 v[36:51], v[188:191], v[84:87], v[36:51]
    v_mfma_f32_32x32x16_bf16 v[20:35], v[184:187], v[84:87], v[20:35]
    s_waitcnt vmcnt(7)
    v_mfma_f32_32x32x16_bf16 v[36:51], v[196:199], v[88:91], v[36:51]
    v_mfma_f32_32x32x16_bf16 v[20:35], v[192:195], v[88:91], v[20:35]
    s_waitcnt vmcnt(6)
    v_mfma_f32_32x32x16_bf16 v[36:51], v[204:207], v[92:95], v[36:51]
    v_mfma_f32_32x32x16_bf16 v[20:35], v[200:203], v[92:95], v[20:35]
    s_waitcnt vmcnt(5)
    v_mfma_f32_32x32x16_bf16 v[36:51], v[212:215], v[96:99], v[36:51]
    v_mfma_f32_32x32x16_bf16 v[20:35], v[208:211], v[96:99], v[20:35]
    s_waitcnt vmcnt(4)
    v_mfma_f32_32x32x16_bf16 v[36:51], v[220:223], v[100:103], v[36:51]
    v_mfma_f32_32x32x16_bf16 v[20:35], v[216:219], v[100:103], v[20:35]
    s_waitcnt vmcnt(3)
    v_mfma_f32_32x32x16_bf16 v[36:51], v[228:231], v[104:107], v[36:51]
    s_waitcnt vmcnt(2)
    v_mfma_f32_32x32x16_bf16 v[36:51], v[236:239], v[108:111], v[36:51]
    s_waitcnt vmcnt(1)
    v_mfma_f32_32x32x16_bf16 v[36:51], v[244:247], v[112:115], v[36:51]
    s_waitcnt vmcnt(0)
    v_mfma_f32_32x32x16_bf16 v[36:51], v[252:255], v[116:119], v[36:51]
    v_mfma_f32_32x32x16_bf16 v[20:35], v[224:227], v[104:107], v[20:35]
    v_mfma_f32_32x32x16_bf16 v[20:35], v[232:235], v[108:111], v[20:35]
    v_mov_b32 v16, 0
    v_mov_b32 v17, 0
    s_nop 7
    ds_write_b128 v2, v[36:39] offset:0
    v_mfma_f32_32x32x16_bf16 v[20:35], v[240:243], v[112:115], v[20:35]
    ds_write_b128 v2, v[40:43] offset:1024
    v_mfma_f32_32x32x16_bf16 v[20:35], v[248:251], v[116:119], v[20:35]
    ds_write_b128 v2, v[44:47] offset:2048
    ds_write_b128 v2, v[48:51] offset:3072
    s_waitcnt lgkmcnt(0)
    s_barrier
    ds_read_b128 v[36:39], v3 offset:0
    ds_read_b128 v[40:43], v3 offset:1024
    ds_read_b128 v[44:47], v3 offset:2048
    ds_read_b128 v[48:51], v3 offset:3072
    s_waitcnt lgkmcnt(3)
    s_nop 2
    v_add_f32 v20, v20, v36
    v_add_f32 v21, v21, v37
    v_add_f32 v22, v22, v38
    v_add_f32 v23, v23, v39
    v_cvt_pk_bf16_f32 v8, v20, v21
    v_cvt_pk_bf16_f32 v9, v22, v23
    s_waitcnt lgkmcnt(2)
    v_add_f32 v24, v24, v40
    v_add_f32 v25, v25, v41
    v_add_f32 v26, v26, v42
    v_add_f32 v27, v27, v43
    v_cvt_pk_bf16_f32 v10, v24, v25
    v_cvt_pk_bf16_f32 v11, v26, v27
    s_waitcnt lgkmcnt(1)
    v_add_f32 v28, v28, v44
    v_add_f32 v29, v29, v45
    v_add_f32 v30, v30, v46
    v_add_f32 v31, v31, v47
    v_cvt_pk_bf16_f32 v12, v28, v29
    v_cvt_pk_bf16_f32 v13, v30, v31
    s_waitcnt lgkmcnt(0)
    v_add_f32 v32, v32, v48
    v_add_f32 v33, v33, v49
    v_add_f32 v34, v34, v50
    v_add_f32 v35, v35, v51
    v_cvt_pk_bf16_f32 v14, v32, v33
    v_cvt_pk_bf16_f32 v15, v34, v35
    v_dot2c_f32_bf16 v16, s34, v8
    v_dot2c_f32_bf16 v17, v8, v8
    v_dot2c_f32_bf16 v16, s34, v9
    v_dot2c_f32_bf16 v17, v9, v9
    s_cmp_eq_u32 s3, 0
    s_cbranch_scc1 Lss_56
    buffer_store_dwordx4 v[8:11], v4, s[12:15], s30 offen
Lsd_57:
    v_dot2c_f32_bf16 v16, s34, v10
    v_dot2c_f32_bf16 v17, v10, v10
    v_dot2c_f32_bf16 v16, s34, v11
    v_dot2c_f32_bf16 v17, v11, v11
    v_dot2c_f32_bf16 v16, s34, v12
    v_dot2c_f32_bf16 v17, v12, v12
    s_cmp_eq_u32 s3, 0
    s_cbranch_scc1 Lss_58
    buffer_store_dwordx4 v[12:15], v4, s[12:15], s30 offen offset:1024
Lsd_59:
    v_dot2c_f32_bf16 v16, s34, v13
    v_dot2c_f32_bf16 v17, v13, v13
    v_dot2c_f32_bf16 v16, s34, v14
    v_dot2c_f32_bf16 v17, v14, v14
    v_dot2c_f32_bf16 v16, s34, v15
    v_dot2c_f32_bf16 v17, v15, v15
    s_nop 2
    v_permlane32_swap_b32 v16, v17
    v_add_f32 v16, v16, v17
    s_cmp_eq_u32 s3, 0
    s_cbranch_scc1 Lss_60
    buffer_store_dword v16, v4, s[12:15], s32 offen
Lsd_61:
    v_bfe_u32 v2, v1, 2, 2
    v_lshl_add_u32 v2, v5, 2, v2
    v_mul_u32_u24 v2, 192, v2
    v_bfe_u32 v3, v1, 4, 1
    v_lshl_add_u32 v2, v3, 5, v2
    v_and_b32 v3, 3, v1
    v_lshl_add_u32 v16, v3, 3, v2
    v_add_u32 v16, 64512, v16
    v_add_u32 v17, 49152, v16
    s_lshl_b32 s36, s92, 15
    s_add_u32 s36, s36, s22
    s_add_u32 s36, s36, 0x800000
    s_lshl_b32 s37, s92, 12
    s_add_u32 s37, s37, s22
    s_add_u32 s37, s37, 0x1200000
    v_mov_b32 v2, s8
    v_mov_b32 v3, s9
    v_mov_b32 v7, 0
    s_mov_b64 exec, 1
    s_waitcnt vmcnt(0)
    s_cmp_eq_u32 s3, 0
    s_cbranch_scc1 Lss_62
    buffer_store_dwordx2 v[2:3], v7, s[12:15], s33 offen
Lsd_63:
    s_mov_b64 exec, -1
    v_mov_b32 v3, 162824
    s_add_u32 s29, s29, 1
Loth_64:
    ds_read_b32 v2, v3
    s_waitcnt lgkmcnt(0)
    v_cmp_gt_u32 vcc, s29, v2
    s_nop 4
    s_cbranch_vccnz Loth_64
    buffer_load_dwordx4 v[128:131], v4, s[12:15], s36 offen offset:0 sc1
    buffer_load_dwordx4 v[132:135], v4, s[12:15], s36 offen offset:1024 sc1
    buffer_load_dwordx4 v[136:139], v4, s[12:15], s36 offen offset:2048 sc1
    buffer_load_dwordx4 v[140:143], v4, s[12:15], s36 offen offset:3072 sc1
    s_add_u32 s36, s36, 4096
    buffer_load_dwordx4 v[112:115], v4, s[12:15], s37 offen offset:0 sc1
    buffer_load_dwordx4 v[116:119], v4, s[12:15], s37 offen offset:1024 sc1
    buffer_load_dwordx4 v[120:123], v4, s[12:15], s37 offen offset:2048 sc1
    buffer_load_dwordx4 v[124:127], v4, s[12:15], s37 offen offset:3072 sc1
    buffer_load_dwordx4 v[144:147], v4, s[12:15], s36 offen offset:0 sc1
    buffer_load_dwordx4 v[148:151], v4, s[12:15], s36 offen offset:1024 sc1
    ds_read_b64_tr_b16 v[28:29], v16 offset:0
    ds_read_b64_tr_b16 v[30:31], v16 offset:1536
    ds_read_b64_tr_b16 v[32:33], v16 offset:64
    ds_read_b64_tr_b16 v[34:35], v16 offset:1600
    ds_read_b64_tr_b16 v[36:37], v16 offset:128
    ds_read_b64_tr_b16 v[38:39], v16 offset:1664
    ds_read_b64_tr_b16 v[40:41], v16 offset:3072
    ds_read_b64_tr_b16 v[42:43], v16 offset:4608
    ds_read_b64_tr_b16 v[44:45], v16 offset:3136
    ds_read_b64_tr_b16 v[46:47], v16 offset:4672
    ds_read_b64_tr_b16 v[48:49], v16 offset:3200
    ds_read_b64_tr_b16 v[50:51], v16 offset:4736
    s_waitcnt vmcnt(9) lgkmcnt(6)
    v_mfma_f32_32x32x16_bf16 v[64:79], v[28:31], v[128:131], 0
    ds_read_b64_tr_b16 v[52:53], v16 offset:6144
    ds_read_b64_tr_b16 v[54:55], v16 offset:7680
    buffer_load_dwordx4 v[152:155], v4, s[12:15], s36 offen offset:2048 sc1
    v_mfma_f32_32x32x16_bf16 v[80:95], v[32:35], v[128:131], 0
    ds_read_b64_tr_b16 v[56:57], v16 offset:6208
    ds_read_b64_tr_b16 v[58:59], v16 offset:7744
    buffer_load_dwordx4 v[156:159], v4, s[12:15], s36 offen offset:3072 sc1
    s_add_u32 s36, s36, 4096
    v_mfma_f32_32x32x16_bf16 v[96:111], v[36:39], v[128:131], 0
    ds_read_b64_tr_b16 v[60:61], v16 offset:6272
    ds_read_b64_tr_b16 v[62:63], v16 offset:7808
    s_waitcnt vmcnt(10) lgkmcnt(6)
    v_mfma_f32_32x32x16_bf16 v[64:79], v[40:43], v[132:135], v[64:79]
    ds_read_b64_tr_b16 v[28:29], v16 offset:9216
    ds_read_b64_tr_b16 v[30:31], v16 offset:10752
    buffer_load_dwordx4 v[160:163], v4, s[12:15], s36 offen offset:0 sc1
    v_mfma_f32_32x32x16_bf16 v[80:95], v[44:47], v[132:135], v[80:95]
    ds_read_b64_tr_b16 v[32:33], v16 offset:9280
    ds_read_b64_tr_b16 v[34:35], v16 offset:10816
    buffer_load_dwordx4 v[164:167], v4, s[12:15], s36 offen offset:1024 sc1
    v_mfma_f32_32x32x16_bf16 v[96:111], v[48:51], v[132:135], v[96:111]
    ds_read_b64_tr_b16 v[36:37], v16 offset:9344
    ds_read_b64_tr_b16 v[38:39], v16 offset:10880
    s_waitcnt vmcnt(11) lgkmcnt(6)
    v_mfma_f32_32x32x16_bf16 v[64:79], v[52:55], v[136:139], v[64:79]
    ds_read_b64_tr_b16 v[40:41], v16 offset:12288
    ds_read_b64_tr_b16 v[42:43], v16 offset:13824
    buffer_load_dwordx4 v[168:171], v4, s[12:15], s36 offen offset:2048 sc1
    v_mfma_f32_32x32x16_bf16 v[80:95], v[56:59], v[136:139], v[80:95]
    ds_read_b64_tr_b16 v[44:45], v16 offset:12352
    ds_read_b64_tr_b16 v[46:47], v16 offset:13888
    buffer_load_dwordx4 v[172:175], v4, s[12:15], s36 offen offset:3072 sc1
    s_add_u32 s36, s36, 4096
    v_mfma_f32_32x32x16_bf16 v[96:111], v[60:63], v[136:139], v[96:111]
    ds_read_b64_tr_b16 v[48:49], v16 offset:12416
    ds_read_b64_tr_b16 v[50:51], v16 offset:13952
    s_waitcnt vmcnt(12) lgkmcnt(6)
    v_mfma_f32_32x32x16_bf16 v[64:79], v[28:31], v[140:143], v[64:79]
    ds_read_b64_tr_b16 v[52:53], v16 offset:15360
    ds_read_b64_tr_b16 v[54:55], v16 offset:16896
    buffer_load_dwordx4 v[176:179], v4, s[12:15], s36 offen offset:0 sc1
    v_mfma_f32_32x32x16_bf16 v[80:95], v[32:35], v[140:143], v[80:95]
    ds_read_b64_tr_b16 v[56:57], v16 offset:15424
    ds_read_b64_tr_b16 v[58:59], v16 offset:16960
    buffer_load_dwordx4 v[180:183], v4, s[12:15], s36 offen offset:1024 sc1
    v_mfma_f32_32x32x16_bf16 v[96:111], v[36:39], v[140:143], v[96:111]
    ds_read_b64_tr_b16 v[60:61], v16 offset:15488
    ds_read_b64_tr_b16 v[62:63], v16 offset:17024
    s_waitcnt vmcnt(9) lgkmcnt(6)
    v_mfma_f32_32x32x16_bf16 v[64:79], v[40:43], v[144:147], v[64:79]
    ds_read_b64_tr_b16 v[28:29], v16 offset:18432
    ds_read_b64_tr_b16 v[30:31], v16 offset:19968
    buffer_load_dwordx4 v[184:187], v4, s[12:15], s36 offen offset:2048 sc1
    v_mfma_f32_32x32x16_bf16 v[80:95], v[44:47], v[144:147], v[80:95]
    ds_read_b64_tr_b16 v[32:33], v16 offset:18496
    ds_read_b64_tr_b16 v[34:35], v16 offset:20032
    v_mfma_f32_32x32x16_bf16 v[96:111], v[48:51], v[144:147], v[96:111]
    ds_read_b64_tr_b16 v[36:37], v16 offset:18560
    ds_read_b64_tr_b16 v[38:39], v16 offset:20096
    s_waitcnt vmcnt(9) lgkmcnt(6)
    v_mfma_f32_32x32x16_bf16 v[64:79], v[52:55], v[148:151], v[64:79]
    ds_read_b64_tr_b16 v[40:41], v16 offset:21504
    ds_read_b64_tr_b16 v[42:43], v16 offset:23040
    buffer_load_dwordx4 v[188:191], v4, s[12:15], s36 offen offset:3072 sc1
    s_add_u32 s36, s36, 4096
    v_mfma_f32_32x32x16_bf16 v[80:95], v[56:59], v[148:151], v[80:95]
    ds_read_b64_tr_b16 v[44:45], v16 offset:21568
    ds_read_b64_tr_b16 v[46:47], v16 offset:23104
    v_mfma_f32_32x32x16_bf16 v[96:111], v[60:63], v[148:151], v[96:111]
    ds_read_b64_tr_b16 v[48:49], v16 offset:21632
    ds_read_b64_tr_b16 v[50:51], v16 offset:23168
    s_waitcnt vmcnt(9) lgkmcnt(6)
    v_mfma_f32_32x32x16_bf16 v[64:79], v[28:31], v[152:155], v[64:79]
    ds_read_b64_tr_b16 v[52:53], v16 offset:24576
    ds_read_b64_tr_b16 v[54:55], v16 offset:26112
    buffer_load_dwordx4 v[192:195], v4, s[12:15], s36 offen offset:0 sc1
    v_mfma_f32_32x32x16_bf16 v[80:95], v[32:35], v[152:155], v[80:95]
    ds_read_b64_tr_b16 v[56:57], v16 offset:24640
    ds_read_b64_tr_b16 v[58:59], v16 offset:26176
    v_mfma_f32_32x32x16_bf16 v[96:111], v[36:39], v[152:155], v[96:111]
    ds_read_b64_tr_b16 v[60:61], v16 offset:24704
    ds_read_b64_tr_b16 v[62:63], v16 offset:26240
    s_waitcnt vmcnt(9) lgkmcnt(6)
    v_mfma_f32_32x32x16_bf16 v[64:79], v[40:43], v[156:159], v[64:79]
    ds_read_b64_tr_b16 v[28:29], v16 offset:27648
    ds_read_b64_tr_b16 v[30:31], v16 offset:29184
    buffer_load_dwordx4 v[196:199], v4, s[12:15], s36 offen offset:1024 sc1
    v_mfma_f32_32x32x16_bf16 v[80:95], v[44:47], v[156:159], v[80:95]
    ds_read_b64_tr_b16 v[32:33], v16 offset:27712
    ds_read_b64_tr_b16 v[34:35], v16 offset:29248
    v_mfma_f32_32x32x16_bf16 v[96:111], v[48:51], v[156:159], v[96:111]
    ds_read_b64_tr_b16 v[36:37], v16 offset:27776
    ds_read_b64_tr_b16 v[38:39], v16 offset:29312
    s_waitcnt vmcnt(9) lgkmcnt(6)
    v_mfma_f32_32x32x16_bf16 v[64:79], v[52:55], v[160:163], v[64:79]
    ds_read_b64_tr_b16 v[40:41], v16 offset:30720
    ds_read_b64_tr_b16 v[42:43], v16 offset:32256
    buffer_load_dwordx4 v[200:203], v4, s[12:15], s36 offen offset:2048 sc1
    v_add_f32 v112, v112, v114
    v_mfma_f32_32x32x16_bf16 v[80:95], v[56:59], v[160:163], v[80:95]
    ds_read_b64_tr_b16 v[44:45], v16 offset:30784
    ds_read_b64_tr_b16 v[46:47], v16 offset:32320
    v_add_f32 v113, v113, v115
    v_mfma_f32_32x32x16_bf16 v[96:111], v[60:63], v[160:163], v[96:111]
    ds_read_b64_tr_b16 v[48:49], v16 offset:30848
    ds_read_b64_tr_b16 v[50:51], v16 offset:32384
    v_add_f32 v112, v112, v116
    s_waitcnt vmcnt(9) lgkmcnt(6)
    v_mfma_f32_32x32x16_bf16 v[64:79], v[28:31], v[164:167], v[64:79]
    ds_read_b64_tr_b16 v[52:53], v16 offset:33792
    ds_read_b64_tr_b16 v[54:55], v16 offset:35328
    buffer_load_dwordx4 v[204:207], v4, s[12:15], s36 offen offset:3072 sc1
    s_add_u32 s36, s36, 4096
    v_add_f32 v113, v113, v117
    v_mfma_f32_32x32x16_bf16 v[80:95], v[32:35], v[164:167], v[80:95]
    ds_read_b64_tr_b16 v[56:57], v16 offset:33856
    ds_read_b64_tr_b16 v[58:59], v16 offset:35392
    v_add_f32 v112, v112, v118
    v_add_f32 v113, v113, v119
    v_mfma_f32_32x32x16_bf16 v[96:111], v[36:39], v[164:167], v[96:111]
    ds_read_b64_tr_b16 v[60:61], v16 offset:33920
    ds_read_b64_tr_b16 v[62:63], v16 offset:35456
    v_add_f32 v112, v112, v120
    s_waitcnt vmcnt(9) lgkmcnt(6)
    v_mfma_f32_32x32x16_bf16 v[64:79], v[40:43], v[168:171], v[64:79]
    ds_read_b64_tr_b16 v[28:29], v16 offset:36864
    ds_read_b64_tr_b16 v[30:31], v16 offset:38400
    buffer_load_dwordx4 v[208:211], v4, s[12:15], s36 offen offset:0 sc1
    v_add_f32 v113, v113, v121
    v_mfma_f32_32x32x16_bf16 v[80:95], v[44:47], v[168:171], v[80:95]
    ds_read_b64_tr_b16 v[32:33], v16 offset:36928
    ds_read_b64_tr_b16 v[34:35], v16 offset:38464
    v_add_f32 v112, v112, v122
    v_mfma_f32_32x32x16_bf16 v[96:111], v[48:51], v[168:171], v[96:111]
    ds_read_b64_tr_b16 v[36:37], v16 offset:36992
    ds_read_b64_tr_b16 v[38:39], v16 offset:38528
    v_add_f32 v113, v113, v123
    v_add_f32 v112, v112, v124
    s_waitcnt vmcnt(9) lgkmcnt(6)
    v_mfma_f32_32x32x16_bf16 v[64:79], v[52:55], v[172:175], v[64:79]
    ds_read_b64_tr_b16 v[40:41], v16 offset:39936
    ds_read_b64_tr_b16 v[42:43], v16 offset:41472
    buffer_load_dwordx4 v[212:215], v4, s[12:15], s36 offen offset:1024 sc1
    v_add_f32 v113, v113, v125
    v_mfma_f32_32x32x16_bf16 v[80:95], v[56:59], v[172:175], v[80:95]
    ds_read_b64_tr_b16 v[44:45], v16 offset:40000
    ds_read_b64_tr_b16 v[46:47], v16 offset:41536
    v_add_f32 v112, v112, v126
    v_mfma_f32_32x32x16_bf16 v[96:111], v[60:63], v[172:175], v[96:111]
    ds_read_b64_tr_b16 v[48:49], v16 offset:40064
    ds_read_b64_tr_b16 v[50:51], v16 offset:41600
    v_add_f32 v113, v113, v127
    s_waitcnt vmcnt(9) lgkmcnt(6)
    v_mfma_f32_32x32x16_bf16 v[64:79], v[28:31], v[176:179], v[64:79]
    ds_read_b64_tr_b16 v[52:53], v16 offset:43008
    ds_read_b64_tr_b16 v[54:55], v16 offset:44544
    buffer_load_dwordx4 v[216:219], v4, s[12:15], s36 offen offset:2048 sc1
    v_add_f32 v112, v112, v113
    v_mov_b32 v113, v112
    v_mfma_f32_32x32x16_bf16 v[80:95], v[32:35], v[176:179], v[80:95]
    ds_read_b64_tr_b16 v[56:57], v16 offset:43072
    ds_read_b64_tr_b16 v[58:59], v16 offset:44608
    s_nop 0
    v_mfma_f32_32x32x16_bf16 v[96:111], v[36:39], v[176:179], v[96:111]
    ds_read_b64_tr_b16 v[60:61], v16 offset:43136
    ds_read_b64_tr_b16 v[62:63], v16 offset:44672
    v_permlane32_swap_b32 v112, v113
    s_waitcnt vmcnt(9) lgkmcnt(6)
    v_mfma_f32_32x32x16_bf16 v[64:79], v[40:43], v[180:183], v[64:79]
    ds_read_b64_tr_b16 v[28:29], v16 offset:46080
    ds_read_b64_tr_b16 v[30:31], v16 offset:47616
    buffer_load_dwordx4 v[220:223], v4, s[12:15], s36 offen offset:3072 sc1
    s_add_u32 s36, s36, 4096
    v_mul_f32 v112, 0xbb000000, v112
    v_mfma_f32_32x32x16_bf16 v[80:95], v[44:47], v[180:183], v[80:95]
    ds_read_b64_tr_b16 v[32:33], v16 offset:46144
    ds_read_b64_tr_b16 v[34:35], v16 offset:47680
    v_mul_f32 v113, 0x3b000000, v113
    v_fma_f32 v113, -v112, v112, v113
    v_mfma_f32_32x32x16_bf16 v[96:111], v[48:51], v[180:183], v[96:111]
    ds_read_b64_tr_b16 v[36:37], v16 offset:46208
    ds_read_b64_tr_b16 v[38:39], v16 offset:47744
    v_max_f32 v113, 0, v113
    s_waitcnt vmcnt(9) lgkmcnt(6)
    v_mfma_f32_32x32x16_bf16 v[64:79], v[52:55], v[184:187], v[64:79]
    ds_read_b64_tr_b16 v[40:41], v17 offset:0
    ds_read_b64_tr_b16 v[42:43], v17 offset:1536
    buffer_load_dwordx4 v[224:227], v4, s[12:15], s36 offen offset:0 sc1
    v_add_f32 v113, 0x3727c5ac, v113
    v_mfma_f32_32x32x16_bf16 v[80:95], v[56:59], v[184:187], v[80:95]
    ds_read_b64_tr_b16 v[44:45], v17 offset:64
    ds_read_b64_tr_b16 v[46:47], v17 offset:1600
    v_rsq_f32 v21, v113
    v_mfma_f32_32x32x16_bf16 v[96:111], v[60:63], v[184:187], v[96:111]
    ds_read_b64_tr_b16 v[48:49], v17 offset:128
    ds_read_b64_tr_b16 v[50:51], v17 offset:1664
    v_cvt_pk_bf16_f32 v24, v112, v112
    v_mul_f32 v22, v113, v21
    s_waitcnt vmcnt(9) lgkmcnt(6)
    v_mfma_f32_32x32x16_bf16 v[64:79], v[28:31], v[188:191], v[64:79]
    ds_read_b64_tr_b16 v[52:53], v17 offset:3072
    ds_read_b64_tr_b16 v[54:55], v17 offset:4608
    buffer_load_dwordx4 v[228:231], v4, s[12:15], s36 offen offset:1024 sc1
    v_and_b32 v25, 0xffff0000, v24
    v_mfma_f32_32x32x16_bf16 v[80:95], v[32:35], v[188:191], v[80:95]
    ds_read_b64_tr_b16 v[56:57], v17 offset:3136
    ds_read_b64_tr_b16 v[58:59], v17 offset:4672
    v_sub_f32 v112, v112, v25
    v_mfma_f32_32x32x16_bf16 v[96:111], v[36:39], v[188:191], v[96:111]
    ds_read_b64_tr_b16 v[60:61], v17 offset:3200
    ds_read_b64_tr_b16 v[62:63], v17 offset:4736
    v_cvt_pk_bf16_f32 v24, v25, v112
    s_waitcnt vmcnt(9) lgkmcnt(6)
    v_mfma_f32_32x32x16_bf16 v[64:79], v[40:43], v[192:195], v[64:79]
    ds_read_b64_tr_b16 v[28:29], v17 offset:6144
    ds_read_b64_tr_b16 v[30:31], v17 offset:7680
    buffer_load_dwordx4 v[232:235], v4, s[12:15], s36 offen offset:2048 sc1
    v_cvt_pk_bf16_f32 v27, v25, v22
    v_mfma_f32_32x32x16_bf16 v[80:95], v[44:47], v[192:195], v[80:95]
    ds_read_b64_tr_b16 v[32:33], v17 offset:6208
    ds_read_b64_tr_b16 v[34:35], v17 offset:7744
    v_and_b32 v112, 0xffff0000, v27
    v_sub_f32 v112, v22, v112
    v_mfma_f32_32x32x16_bf16 v[96:111], v[48:51], v[192:195], v[96:111]
    ds_read_b64_tr_b16 v[36:37], v17 offset:6272
    ds_read_b64_tr_b16 v[38:39], v17 offset:7808
    v_cvt_pk_bf16_f32 v26, v25, v112
    s_waitcnt vmcnt(9) lgkmcnt(6)
    v_mfma_f32_32x32x16_bf16 v[64:79], v[52:55], v[196:199], v[64:79]
    ds_read_b64_tr_b16 v[40:41], v17 offset:9216
    ds_read_b64_tr_b16 v[42:43], v17 offset:10752
    buffer_load_dwordx4 v[236:239], v4, s[12:15], s36 offen offset:3072 sc1
    s_add_u32 s36, s36, 4096
    v_and_b32 v113, 0xffff0000, v26
    v_mfma_f32_32x32x16_bf16 v[80:95], v[56:59], v[196:199], v[80:95]
    ds_read_b64_tr_b16 v[44:45], v17 offset:9280
    ds_read_b64_tr_b16 v[46:47], v17 offset:10816
    v_sub_f32 v113, v112, v113
    v_mfma_f32_32x32x16_bf16 v[96:111], v[60:63], v[196:199], v[96:111]
    ds_read_b64_tr_b16 v[48:49], v17 offset:9344
    ds_read_b64_tr_b16 v[50:51], v17 offset:10880
    v_cvt_pk_bf16_f32 v113, v25, v113
    v_cmp_eq_u32 vcc, 0, v5
    s_waitcnt vmcnt(9) lgkmcnt(6)
    v_mfma_f32_32x32x16_bf16 v[64:79], v[28:31], v[200:203], v[64:79]
    ds_read_b64_tr_b16 v[52:53], v17 offset:12288
    ds_read_b64_tr_b16 v[54:55], v17 offset:13824
    buffer_load_dwordx4 v[240:243], v4, s[12:15], s36 offen offset:0 sc1
    v_cndmask_b32 v25, v113, v27, vcc
    v_mfma_f32_32x32x16_bf16 v[80:95], v[32:35], v[200:203], v[80:95]
    ds_read_b64_tr_b16 v[56:57], v17 offset:12352
    ds_read_b64_tr_b16 v[58:59], v17 offset:13888
    v_mov_b32 v27, v26
    v_mfma_f32_32x32x16_bf16 v[96:111], v[36:39], v[200:203], v[96:111]
    ds_read_b64_tr_b16 v[60:61], v17 offset:12416
    ds_read_b64_tr_b16 v[62:63], v17 offset:13952
    v_mov_b32 v26, v24
    s_waitcnt vmcnt(9) lgkmcnt(6)
    v_mfma_f32_32x32x16_bf16 v[64:79], v[40:43], v[204:207], v[64:79]
    ds_read_b64_tr_b16 v[28:29], v17 offset:15360
    ds_read_b64_tr_b16 v[30:31], v17 offset:16896
    buffer_load_dwordx4 v[244:247], v4, s[12:15], s36 offen offset:1024 sc1
    v_mul_f32 v23, 0x3fb8aa3b, v21
    v_mul_f32 v18, -2.0, v21
    v_mfma_f32_32x32x16_bf16 v[80:95], v[44:47], v[204:207], v[80:95]
    ds_read_b64_tr_b16 v[32:33], v17 offset:15424
    ds_read_b64_tr_b16 v[34:35], v17 offset:16960
    s_mul_i32 s33, s92, 88064
    s_mul_i32 s31, s93, 6144
    s_add_u32 s33, s33, s31
    v_mfma_f32_32x32x16_bf16 v[96:111], v[48:51], v[204:207], v[96:111]
    ds_read_b64_tr_b16 v[36:37], v17 offset:15488
    ds_read_b64_tr_b16 v[38:39], v17 offset:17024
    s_add_u32 s33, s33, s22
    s_add_u32 s33, s33, 0xc00000
    s_waitcnt vmcnt(9) lgkmcnt(6)
    v_mfma_f32_32x32x16_bf16 v[64:79], v[52:55], v[208:211], v[64:79]
    ds_read_b64_tr_b16 v[40:41], v17 offset:18432
    ds_read_b64_tr_b16 v[42:43], v17 offset:19968
    buffer_load_dwordx4 v[248:251], v4, s[12:15], s36 offen offset:2048 sc1
    s_mov_b32 s39, 0x42200000
    s_mov_b32 s31, 0x70000000
    v_mfma_f32_32x32x16_bf16 v[80:95], v[56:59], v[208:211], v[80:95]
    ds_read_b64_tr_b16 v[44:45], v17 offset:18496
    ds_read_b64_tr_b16 v[46:47], v17 offset:20032
    s_add_u32 s34, s33, 2048
    s_add_u32 s35, s33, 4096
    s_cmp_ge_u32 s93, 14
    s_cselect_b32 s34, s31, s34
    s_cselect_b32 s35, s31, s35
    v_mfma_f32_32x32x16_bf16 v[96:111], v[60:63], v[208:211], v[96:111]
    ds_read_b64_tr_b16 v[48:49], v17 offset:18560
    ds_read_b64_tr_b16 v[50:51], v17 offset:20096
    s_cmp_ge_u32 s93, 15
    s_cselect_b32 s33, s31, s33
    s_waitcnt vmcnt(9) lgkmcnt(6)
    v_mfma_f32_32x32x16_bf16 v[64:79], v[28:31], v[212:215], v[64:79]
    ds_read_b64_tr_b16 v[52:53], v17 offset:21504
    ds_read_b64_tr_b16 v[54:55], v17 offset:23040
    buffer_load_dwordx4 v[252:255], v4, s[12:15], s36 offen offset:3072 sc1
    s_add_u32 s36, s36, 4096
    s_lshr_b32 s32, s92, 2
    s_lshl_b32 s32, s32, 9
    v_mfma_f32_32x32x16_bf16 v[80:95], v[32:35], v[212:215], v[80:95]
    s_barrier
    ds_read_b64_tr_b16 v[56:57], v17 offset:21568
    ds_read_b64_tr_b16 v[58:59], v17 offset:23104
    s_lshl_b32 s31, s21, 3
    s_add_u32 s32, s32, s31
    v_mfma_f32_32x32x16_bf16 v[96:111], v[36:39], v[212:215], v[96:111]
    ds_read_b64_tr_b16 v[60:61], v17 offset:21632
    ds_read_b64_tr_b16 v[62:63], v17 offset:23168
    s_lshl_b32 s31, s93, 5
    s_add_u32 s32, s32, s31
    s_add_u32 s32, s32, s22
    s_add_u32 s32, s32, 0x1306000
    s_waitcnt vmcnt(9) lgkmcnt(6)
    v_mfma_f32_32x32x16_bf16 v[64:79], v[40:43], v[216:219], v[64:79]
    ds_read_b64_tr_b16 v[28:29], v17 offset:24576
    ds_read_b64_tr_b16 v[30:31], v17 offset:26112
    v_mfma_f32_32x32x16_bf16 v[80:95], v[44:47], v[216:219], v[80:95]
    ds_read_b64_tr_b16 v[32:33], v17 offset:24640
    ds_read_b64_tr_b16 v[34:35], v17 offset:26176
    v_mfma_f32_32x32x16_bf16 v[96:111], v[48:51], v[216:219], v[96:111]
    ds_read_b64_tr_b16 v[36:37], v17 offset:24704
    ds_read_b64_tr_b16 v[38:39], v17 offset:26240
    s_waitcnt vmcnt(8) lgkmcnt(6)
    v_mfma_f32_32x32x16_bf16 v[64:79], v[52:55], v[220:223], v[64:79]
    ds_read_b64_tr_b16 v[40:41], v17 offset:27648
    ds_read_b64_tr_b16 v[42:43], v17 offset:29184
    v_mfma_f32_32x32x16_bf16 v[80:95], v[56:59], v[220:223], v[80:95]
    ds_read_b64_tr_b16 v[44:45], v17 offset:30720
    ds_read_b64_tr_b16 v[46:47], v17 offset:32256
    v_mfma_f32_32x32x16_bf16 v[96:111], v[60:63], v[220:223], v[96:111]
    ds_read_b64_tr_b16 v[48:49], v17 offset:33792
    ds_read_b64_tr_b16 v[50:51], v17 offset:35328
    s_waitcnt vmcnt(7) lgkmcnt(6)
    v_mfma_f32_32x32x16_bf16 v[64:79], v[28:31], v[224:227], v[64:79]
    ds_read_b64_tr_b16 v[52:53], v17 offset:36864
    ds_read_b64_tr_b16 v[54:55], v17 offset:38400
    v_mfma_f32_32x32x16_bf16 v[80:95], v[32:35], v[224:227], v[80:95]
    ds_read_b64_tr_b16 v[56:57], v17 offset:39936
    ds_read_b64_tr_b16 v[58:59], v17 offset:41472
    v_mfma_f32_32x32x16_bf16 v[96:111], v[36:39], v[224:227], v[96:111]
    ds_read_b64_tr_b16 v[60:61], v17 offset:43008
    ds_read_b64_tr_b16 v[62:63], v17 offset:44544
    s_waitcnt vmcnt(6) lgkmcnt(10)
    v_mfma_f32_32x32x16_bf16 v[64:79], v[40:43], v[228:231], v[64:79]
    ds_read_b64_tr_b16 v[28:29], v17 offset:46080
    ds_read_b64_tr_b16 v[30:31], v17 offset:47616
    s_waitcnt vmcnt(5) lgkmcnt(10)
    v_mfma_f32_32x32x16_bf16 v[64:79], v[44:47], v[232:235], v[64:79]
    ds_read_b128 v[32:35], v4 offset:61440
    s_waitcnt vmcnt(4) lgkmcnt(9)
    v_mfma_f32_32x32x16_bf16 v[64:79], v[48:51], v[236:239], v[64:79]
    ds_read_b64_tr_b16 v[36:37], v17 offset:27712
    ds_read_b64_tr_b16 v[38:39], v17 offset:29248
    s_waitcnt vmcnt(3) lgkmcnt(9)
    v_mfma_f32_32x32x16_bf16 v[64:79], v[52:55], v[240:243], v[64:79]
    ds_read_b64_tr_b16 v[40:41], v17 offset:30784
    ds_read_b64_tr_b16 v[42:43], v17 offset:32320
    s_waitcnt vmcnt(2) lgkmcnt(9)
    v_mfma_f32_32x32x16_bf16 v[64:79], v[56:59], v[244:247], v[64:79]
    ds_read_b64_tr_b16 v[44:45], v17 offset:33856
    ds_read_b64_tr_b16 v[46:47], v17 offset:35392
    s_waitcnt vmcnt(1) lgkmcnt(9)
    v_mfma_f32_32x32x16_bf16 v[64:79], v[60:63], v[248:251], v[64:79]
    ds_read_b64_tr_b16 v[48:49], v17 offset:36928
    ds_read_b64_tr_b16 v[50:51], v17 offset:38464
    s_waitcnt vmcnt(0) lgkmcnt(9)
    v_mfma_f32_32x32x16_bf16 v[64:79], v[28:31], v[252:255], v[64:79]
    ds_read_b64_tr_b16 v[52:53], v17 offset:40000
    ds_read_b64_tr_b16 v[54:55], v17 offset:41536
    s_waitcnt lgkmcnt(10)
    v_mfma_f32_32x32x16_bf16 v[64:79], v[32:35], v[24:27], v[64:79]
    ds_read_b64_tr_b16 v[56:57], v17 offset:43072
    ds_read_b64_tr_b16 v[58:59], v17 offset:44608
    s_waitcnt lgkmcnt(10)
    v_mfma_f32_32x32x16_bf16 v[80:95], v[36:39], v[228:231], v[80:95]
    ds_read_b64_tr_b16 v[60:61], v17 offset:46144
    ds_read_b64_tr_b16 v[62:63], v17 offset:47680
    s_waitcnt lgkmcnt(10)
    v_mfma_f32_32x32x16_bf16 v[80:95], v[40:43], v[232:235], v[80:95]
    ds_read_b128 v[28:31], v4 offset:62464
    s_waitcnt lgkmcnt(9)
    v_mfma_f32_32x32x16_bf16 v[80:95], v[44:47], v[236:239], v[80:95]
    ds_read_b64_tr_b16 v[32:33], v17 offset:27776
    ds_read_b64_tr_b16 v[34:35], v17 offset:29312
    v_mul_f32 v112, v23, v64
    v_mul_f32 v113, v23, v65
    v_mul_f32 v114, v23, v66
    v_mul_f32 v115, v23, v67
    v_mul_f32 v116, v23, v68
    s_waitcnt lgkmcnt(9)
    v_mfma_f32_32x32x16_bf16 v[80:95], v[48:51], v[240:243], v[80:95]
    ds_read_b64_tr_b16 v[36:37], v17 offset:30848
    ds_read_b64_tr_b16 v[38:39], v17 offset:32384
    v_mul_f32 v117, v23, v69
    v_mul_f32 v118, v23, v70
    v_mul_f32 v119, v23, v71
    v_exp_f32 v112, v112
    v_exp_f32 v113, v113
    s_waitcnt lgkmcnt(9)
    v_mfma_f32_32x32x16_bf16 v[80:95], v[52:55], v[244:247], v[80:95]
    ds_read_b64_tr_b16 v[40:41], v17 offset:33920
    ds_read_b64_tr_b16 v[42:43], v17 offset:35456
    v_exp_f32 v114, v114
    v_exp_f32 v115, v115
    v_exp_f32 v116, v116
    v_exp_f32 v117, v117
    v_exp_f32 v118, v118
    s_waitcnt lgkmcnt(9)
    v_mfma_f32_32x32x16_bf16 v[80:95], v[56:59], v[248:251], v[80:95]
    ds_read_b64_tr_b16 v[44:45], v17 offset:36992
    ds_read_b64_tr_b16 v[46:47], v17 offset:38528
    v_exp_f32 v119, v119
    v_add_f32 v120, 2.0, v112
    v_add_f32 v121, 2.0, v113
    v_add_f32 v122, 2.0, v114
    v_add_f32 v123, 2.0, v115
    s_waitcnt lgkmcnt(9)
    v_mfma_f32_32x32x16_bf16 v[80:95], v[60:63], v[252:255], v[80:95]
    ds_read_b64_tr_b16 v[48:49], v17 offset:40064
    ds_read_b64_tr_b16 v[50:51], v17 offset:41600
    v_add_f32 v124, 2.0, v116
    v_add_f32 v125, 2.0, v117
    v_add_f32 v126, 2.0, v118
    v_add_f32 v127, 2.0, v119
    v_fma_f32 v120, v112, v120, 2.0
    s_waitcnt lgkmcnt(10)
    v_mfma_f32_32x32x16_bf16 v[80:95], v[28:31], v[24:27], v[80:95]
    ds_read_b64_tr_b16 v[52:53], v17 offset:43136
    ds_read_b64_tr_b16 v[54:55], v17 offset:44672
    v_fma_f32 v121, v113, v121, 2.0
    v_fma_f32 v122, v114, v122, 2.0
    v_fma_f32 v123, v115, v123, 2.0
    v_fma_f32 v124, v116, v124, 2.0
    v_fma_f32 v125, v117, v125, 2.0
    s_waitcnt lgkmcnt(10)
    v_mfma_f32_32x32x16_bf16 v[96:111], v[32:35], v[228:231], v[96:111]
    ds_read_b64_tr_b16 v[56:57], v17 offset:46208
    ds_read_b64_tr_b16 v[58:59], v17 offset:47744
    v_fma_f32 v126, v118, v126, 2.0
    v_fma_f32 v127, v119, v127, 2.0
    v_rcp_f32 v120, v120
    v_rcp_f32 v121, v121
    v_rcp_f32 v122, v122
    s_waitcnt lgkmcnt(10)
    v_mfma_f32_32x32x16_bf16 v[96:111], v[36:39], v[232:235], v[96:111]
    ds_read_b128 v[60:63], v4 offset:63488
    v_rcp_f32 v123, v123
    v_rcp_f32 v124, v124
    v_rcp_f32 v125, v125
    v_rcp_f32 v126, v126
    v_rcp_f32 v127, v127
    s_waitcnt lgkmcnt(9)
    v_mfma_f32_32x32x16_bf16 v[96:111], v[40:43], v[236:239], v[96:111]
    v_fma_f32 v120, v120, v18, v21
    v_fma_f32 v121, v121, v18, v21
    v_fma_f32 v122, v122, v18, v21
    v_fma_f32 v123, v123, v18, v21
    v_fma_f32 v124, v124, v18, v21
    s_waitcnt lgkmcnt(7)
    v_mfma_f32_32x32x16_bf16 v[96:111], v[44:47], v[240:243], v[96:111]
    v_fma_f32 v125, v125, v18, v21
    v_fma_f32 v126, v126, v18, v21
    v_fma_f32 v127, v127, v18, v21
    v_mul_f32 v64, v64, v120
    v_mul_f32 v65, v65, v121
    s_waitcnt lgkmcnt(5)
    v_mfma_f32_32x32x16_bf16 v[96:111], v[48:51], v[244:247], v[96:111]
    v_mul_f32 v66, v66, v122
    v_mul_f32 v67, v67, v123
    v_mul_f32 v68, v68, v124
    v_mul_f32 v69, v69, v125
    v_mul_f32 v70, v70, v126
    s_waitcnt lgkmcnt(3)
    v_mfma_f32_32x32x16_bf16 v[96:111], v[52:55], v[248:251], v[96:111]
    v_mul_f32 v71, v71, v127
    v_cvt_pk_bf16_f32 v128, v64, v65
    v_cvt_pk_bf16_f32 v129, v66, v67
    v_cvt_pk_bf16_f32 v130, v68, v69
    v_cvt_pk_bf16_f32 v131, v70, v71
    s_waitcnt lgkmcnt(1)
    v_mfma_f32_32x32x16_bf16 v[96:111], v[56:59], v[252:255], v[96:111]
    s_cmp_eq_u32 s3, 0
    s_cbranch_scc1 Lss_65
    buffer_store_dwordx4 v[128:131], v4, s[12:15], s33 offen offset:0
Lsd_66:
    v_mul_f32 v112, v23, v72
    v_mul_f32 v113, v23, v73
    v_mul_f32 v114, v23, v74
    v_mul_f32 v115, v23, v75
    s_waitcnt lgkmcnt(0)
    v_mfma_f32_32x32x16_bf16 v[96:111], v[60:63], v[24:27], v[96:111]
    v_mul_f32 v116, v23, v76
    v_mul_f32 v117, v23, v77
    v_mul_f32 v118, v23, v78
    v_mul_f32 v119, v23, v79
    v_exp_f32 v112, v112
    v_mov_b32 v2, 1
    v_mov_b32 v3, 162816
    s_mov_b64 exec, 1
    ds_add_u32 v3, v2 offset:36
    s_mov_b64 exec, -1
    v_exp_f32 v113, v113
    v_exp_f32 v114, v114
    v_exp_f32 v115, v115
    v_exp_f32 v116, v116
    v_exp_f32 v117, v117
    v_exp_f32 v118, v118
    v_exp_f32 v119, v119
    v_add_f32 v120, 2.0, v112
    v_add_f32 v121, 2.0, v113
    v_add_f32 v122, 2.0, v114
    v_add_f32 v123, 2.0, v115
    v_add_f32 v124, 2.0, v116
    v_add_f32 v125, 2.0, v117
    v_add_f32 v126, 2.0, v118
    v_add_f32 v127, 2.0, v119
    v_fma_f32 v120, v112, v120, 2.0
    v_fma_f32 v121, v113, v121, 2.0
    v_fma_f32 v122, v114, v122, 2.0
    v_fma_f32 v123, v115, v123, 2.0
    v_fma_f32 v124, v116, v124, 2.0
    v_fma_f32 v125, v117, v125, 2.0
    v_fma_f32 v126, v118, v126, 2.0
    v_fma_f32 v127, v119, v127, 2.0
    v_rcp_f32 v120, v120
    v_rcp_f32 v121, v121
    v_rcp_f32 v122, v122
    v_rcp_f32 v123, v123
    v_rcp_f32 v124, v124
    v_rcp_f32 v125, v125
    v_rcp_f32 v126, v126
    v_rcp_f32 v127, v127
    v_fma_f32 v120, v120, v18, v21
    v_fma_f32 v121, v121, v18, v21
    v_fma_f32 v122, v122, v18, v21
    v_fma_f32 v123, v123, v18, v21
    v_fma_f32 v124, v124, v18, v21
    v_fma_f32 v125, v125, v18, v21
    v_fma_f32 v126, v126, v18, v21
    v_fma_f32 v127, v127, v18, v21
    v_mul_f32 v72, v72, v120
    v_mul_f32 v73, v73, v121
    v_mul_f32 v74, v74, v122
    v_mul_f32 v75, v75, v123
    v_mul_f32 v76, v76, v124
    v_mul_f32 v77, v77, v125
    v_mul_f32 v78, v78, v126
    v_mul_f32 v79, v79, v127
    v_cvt_pk_bf16_f32 v132, v72, v73
    v_cvt_pk_bf16_f32 v133, v74, v75
    v_cvt_pk_bf16_f32 v134, v76, v77
    v_cvt_pk_bf16_f32 v135, v78, v79
    s_cmp_eq_u32 s3, 0
    s_cbranch_scc1 Lss_67
    buffer_store_dwordx4 v[132:135], v4, s[12:15], s33 offen offset:1024
Lsd_68:
    v_mul_f32 v112, v23, v80
    v_mul_f32 v113, v23, v81
    v_mul_f32 v114, v23, v82
    v_mul_f32 v115, v23, v83
    v_mul_f32 v116, v23, v84
    v_mul_f32 v117, v23, v85
    v_mul_f32 v118, v23, v86
    v_mul_f32 v119, v23, v87
    v_exp_f32 v112, v112
    v_exp_f32 v113, v113
    v_exp_f32 v114, v114
    v_exp_f32 v115, v115
    v_exp_f32 v116, v116
    v_exp_f32 v117, v117
    v_exp_f32 v118, v118
    v_exp_f32 v119, v119
    v_add_f32 v120, 2.0, v112
    v_add_f32 v121, 2.0, v113
    v_add_f32 v122, 2.0, v114
    v_add_f32 v123, 2.0, v115
    v_add_f32 v124, 2.0, v116
    v_add_f32 v125, 2.0, v117
    v_add_f32 v126, 2.0, v118
    v_add_f32 v127, 2.0, v119
    v_fma_f32 v120, v112, v120, 2.0
    v_fma_f32 v121, v113, v121, 2.0
    v_fma_f32 v122, v114, v122, 2.0
    v_fma_f32 v123, v115, v123, 2.0
    v_fma_f32 v124, v116, v124, 2.0
    v_fma_f32 v125, v117, v125, 2.0
    v_fma_f32 v126, v118, v126, 2.0
    v_fma_f32 v127, v119, v127, 2.0
    v_rcp_f32 v120, v120
    v_rcp_f32 v121, v121
    v_rcp_f32 v122, v122
    v_rcp_f32 v123, v123
    v_rcp_f32 v124, v124
    v_rcp_f32 v125, v125
    v_rcp_f32 v126, v126
    v_rcp_f32 v127, v127
    v_fma_f32 v120, v120, v18, v21
    v_fma_f32 v121, v121, v18, v21
    v_fma_f32 v122, v122, v18, v21
    v_fma_f32 v123, v123, v18, v21
    v_fma_f32 v124, v124, v18, v21
    v_fma_f32 v125, v125, v18, v21
    v_fma_f32 v126, v126, v18, v21
    v_fma_f32 v127, v127, v18, v21
    v_mul_f32 v80, v80, v120
    v_mul_f32 v81, v81, v121
    v_mul_f32 v82, v82, v122
    v_mul_f32 v83, v83, v123
    v_mul_f32 v84, v84, v124
    v_mul_f32 v85, v85, v125
    v_mul_f32 v86, v86, v126
    v_mul_f32 v87, v87, v127
    v_cvt_pk_bf16_f32 v136, v80, v81
    v_cvt_pk_bf16_f32 v137, v82, v83
    v_cvt_pk_bf16_f32 v138, v84, v85
    v_cvt_pk_bf16_f32 v139, v86, v87
    s_cmp_eq_u32 s3, 0
    s_cbranch_scc1 Lss_69
    buffer_store_dwordx4 v[136:139], v4, s[12:15], s34 offen offset:0
Lsd_70:
    v_mul_f32 v112, v23, v88
    v_mul_f32 v113, v23, v89
    v_mul_f32 v114, v23, v90
    v_mul_f32 v115, v23, v91
    v_mul_f32 v116, v23, v92
    v_mul_f32 v117, v23, v93
    v_mul_f32 v118, v23, v94
    v_mul_f32 v119, v23, v95
    v_exp_f32 v112, v112
    v_exp_f32 v113, v113
    v_exp_f32 v114, v114
    v_exp_f32 v115, v115
    v_exp_f32 v116, v116
    v_exp_f32 v117, v117
    v_exp_f32 v118, v118
    v_exp_f32 v119, v119
    v_add_f32 v120, 2.0, v112
    v_add_f32 v121, 2.0, v113
    v_add_f32 v122, 2.0, v114
    v_add_f32 v123, 2.0, v115
    v_add_f32 v124, 2.0, v116
    v_add_f32 v125, 2.0, v117
    v_add_f32 v126, 2.0, v118
    v_add_f32 v127, 2.0, v119
    v_fma_f32 v120, v112, v120, 2.0
    v_fma_f32 v121, v113, v121, 2.0
    v_fma_f32 v122, v114, v122, 2.0
    v_fma_f32 v123, v115, v123, 2.0
    v_fma_f32 v124, v116, v124, 2.0
    v_fma_f32 v125, v117, v125, 2.0
    v_fma_f32 v126, v118, v126, 2.0
    v_fma_f32 v127, v119, v127, 2.0
    v_rcp_f32 v120, v120
    v_rcp_f32 v121, v121
    v_rcp_f32 v122, v122
    v_rcp_f32 v123, v123
    v_rcp_f32 v124, v124
    v_rcp_f32 v125, v125
    v_rcp_f32 v126, v126
    v_rcp_f32 v127, v127
    v_fma_f32 v120, v120, v18, v21
    v_fma_f32 v121, v121, v18, v21
    v_fma_f32 v122, v122, v18, v21
    v_fma_f32 v123, v123, v18, v21
    v_fma_f32 v124, v124, v18, v21
    v_fma_f32 v125, v125, v18, v21
    v_fma_f32 v126, v126, v18, v21
    v_fma_f32 v127, v127, v18, v21
    v_mul_f32 v88, v88, v120
    v_mul_f32 v89, v89, v121
    v_mul_f32 v90, v90, v122
    v_mul_f32 v91, v91, v123
    v_mul_f32 v92, v92, v124
    v_mul_f32 v93, v93, v125
    v_mul_f32 v94, v94, v126
    v_mul_f32 v95, v95, v127
    v_cvt_pk_bf16_f32 v140, v88, v89
    v_cvt_pk_bf16_f32 v141, v90, v91
    v_cvt_pk_bf16_f32 v142, v92, v93
    v_cvt_pk_bf16_f32 v143, v94, v95
    s_cmp_eq_u32 s3, 0
    s_cbranch_scc1 Lss_71
    buffer_store_dwordx4 v[140:143], v4, s[12:15], s34 offen offset:1024
Lsd_72:
    v_mul_f32 v112, v23, v96
    v_mul_f32 v113, v23, v97
    v_mul_f32 v114, v23, v98
    v_mul_f32 v115, v23, v99
    v_mul_f32 v116, v23, v100
    v_mul_f32 v117, v23, v101
    v_mul_f32 v118, v23, v102
    v_mul_f32 v119, v23, v103
    v_exp_f32 v112, v112
    v_exp_f32 v113, v113
    v_exp_f32 v114, v114
    v_exp_f32 v115, v115
    v_exp_f32 v116, v116
    v_exp_f32 v117, v117
    v_exp_f32 v118, v118
    v_exp_f32 v119, v119
    v_add_f32 v120, 2.0, v112
    v_add_f32 v121, 2.0, v113
    v_add_f32 v122, 2.0, v114
    v_add_f32 v123, 2.0, v115
    v_add_f32 v124, 2.0, v116
    v_add_f32 v125, 2.0, v117
    v_add_f32 v126, 2.0, v118
    v_add_f32 v127, 2.0, v119
    v_fma_f32 v120, v112, v120, 2.0
    v_fma_f32 v121, v113, v121, 2.0
    v_fma_f32 v122, v114, v122, 2.0
    v_fma_f32 v123, v115, v123, 2.0
    v_fma_f32 v124, v116, v124, 2.0
    v_fma_f32 v125, v117, v125, 2.0
    v_fma_f32 v126, v118, v126, 2.0
    v_fma_f32 v127, v119, v127, 2.0
    v_rcp_f32 v120, v120
    v_rcp_f32 v121, v121
    v_rcp_f32 v122, v122
    v_rcp_f32 v123, v123
    v_rcp_f32 v124, v124
    v_rcp_f32 v125, v125
    v_rcp_f32 v126, v126
    v_rcp_f32 v127, v127
    v_fma_f32 v120, v120, v18, v21
    v_fma_f32 v121, v121, v18, v21
    v_fma_f32 v122, v122, v18, v21
    v_fma_f32 v123, v123, v18, v21
    v_fma_f32 v124, v124, v18, v21
    v_fma_f32 v125, v125, v18, v21
    v_fma_f32 v126, v126, v18, v21
    v_fma_f32 v127, v127, v18, v21
    v_mul_f32 v96, v96, v120
    v_mul_f32 v97, v97, v121
    v_mul_f32 v98, v98, v122
    v_mul_f32 v99, v99, v123
    v_mul_f32 v100, v100, v124
    v_mul_f32 v101, v101, v125
    v_mul_f32 v102, v102, v126
    v_mul_f32 v103, v103, v127
    v_cvt_pk_bf16_f32 v144, v96, v97
    v_cvt_pk_bf16_f32 v145, v98, v99
    v_cvt_pk_bf16_f32 v146, v100, v101
    v_cvt_pk_bf16_f32 v147, v102, v103
    s_cmp_eq_u32 s3, 0
    s_cbranch_scc1 Lss_73
    buffer_store_dwordx4 v[144:147], v4, s[12:15], s35 offen offset:0
Lsd_74:
    v_mul_f32 v112, v23, v104
    v_mul_f32 v113, v23, v105
    v_mul_f32 v114, v23, v106
    v_mul_f32 v115, v23, v107
    v_mul_f32 v116, v23, v108
    v_mul_f32 v117, v23, v109
    v_mul_f32 v118, v23, v110
    v_mul_f32 v119, v23, v111
    v_exp_f32 v112, v112
    v_exp_f32 v113, v113
    v_exp_f32 v114, v114
    v_exp_f32 v115, v115
    v_exp_f32 v116, v116
    v_exp_f32 v117, v117
    v_exp_f32 v118, v118
    v_exp_f32 v119, v119
    v_add_f32 v120, 2.0, v112
    v_add_f32 v121, 2.0, v113
    v_add_f32 v122, 2.0, v114
    v_add_f32 v123, 2.0, v115
    v_add_f32 v124, 2.0, v116
    v_add_f32 v125, 2.0, v117
    v_add_f32 v126, 2.0, v118
    v_add_f32 v127, 2.0, v119
    v_fma_f32 v120, v112, v120, 2.0
    v_fma_f32 v121, v113, v121, 2.0
    v_fma_f32 v122, v114, v122, 2.0
    v_fma_f32 v123, v115, v123, 2.0
    v_fma_f32 v124, v116, v124, 2.0
    v_fma_f32 v125, v117, v125, 2.0
    v_fma_f32 v126, v118, v126, 2.0
    v_fma_f32 v127, v119, v127, 2.0
    v_rcp_f32 v120, v120
    v_rcp_f32 v121, v121
    v_rcp_f32 v122, v122
    v_rcp_f32 v123, v123
    v_rcp_f32 v124, v124
    v_rcp_f32 v125, v125
    v_rcp_f32 v126, v126
    v_rcp_f32 v127, v127
    v_fma_f32 v120, v120, v18, v21
    v_fma_f32 v121, v121, v18, v21
    v_fma_f32 v122, v122, v18, v21
    v_fma_f32 v123, v123, v18, v21
    v_fma_f32 v124, v124, v18, v21
    v_fma_f32 v125, v125, v18, v21
    v_fma_f32 v126, v126, v18, v21
    v_fma_f32 v127, v127, v18, v21
    v_mul_f32 v104, v104, v120
    v_mul_f32 v105, v105, v121
    v_mul_f32 v106, v106, v122
    v_mul_f32 v107, v107, v123
    v_mul_f32 v108, v108, v124
    v_mul_f32 v109, v109, v125
    v_mul_f32 v110, v110, v126
    v_mul_f32 v111, v111, v127
    v_cvt_pk_bf16_f32 v148, v104, v105
    v_cvt_pk_bf16_f32 v149, v106, v107
    v_cvt_pk_bf16_f32 v150, v108, v109
    v_cvt_pk_bf16_f32 v151, v110, v111
    s_cmp_eq_u32 s3, 0
    s_cbranch_scc1 Lss_75
    buffer_store_dwordx4 v[148:151], v4, s[12:15], s35 offen offset:1024
Lsd_76:
    s_nop 1
    s_lshl_b32 s40, s23, 2
    s_and_b32 s41, s24, 3
    s_add_u32 s40, s40, s41
    s_lshl_b32 s40, s40, 1
    s_and_b32 s41, s21, 1
    s_add_u32 s40, s40, s41
    s_lshr_b32 s41, s24, 2
    s_lshr_b32 s42, s21, 1
    s_lshl_b32 s43, s41, 1
    s_add_u32 s43, s43, s42
    s_mul_i32 s36, s40, 88064
    s_mul_i32 s31, s42, 1024
    s_add_u32 s36, s36, s31
    s_add_u32 s36, s36, s22
    s_add_u32 s36, s36, 0xc00000
    v_bfe_u32 v2, v1, 2, 2
    v_lshl_add_u32 v3, v5, 2, v2
    v_lshlrev_b32 v3, 7, v3
    v_bfe_u32 v16, v1, 4, 1
    v_lshl_add_u32 v3, v16, 5, v3
    v_and_b32 v16, 3, v1
    v_lshl_add_u32 v3, v16, 3, v3
    v_lshrrev_b32 v2, 1, v2
    v_xor_b32 v2, s42, v2
    v_lshl_add_u32 v3, v2, 6, v3
    s_mul_i32 s30, s42, 22528
    s_add_u32 s30, s30, 16384
    v_add_u32 v16, s30, v3
    v_xor_b32 v17, 64, v16
    s_mul_i32 s30, s42, 49152
    s_add_u32 s30, s30, 64512
    v_add_u32 v18, s30, v3
    v_xor_b32 v19, 64, v18
    v_mov_b32 v2, s8
    v_mov_b32 v3, s9
    v_mov_b32 v7, 0
    s_mov_b64 exec, 1
    s_waitcnt vmcnt(0)
    s_cmp_eq_u32 s3, 0
    s_cbranch_scc1 Lss_77
    buffer_store_dwordx2 v[2:3], v7, s[12:15], s32 offen
Lsd_78:
    s_mov_b64 exec, -1
    v_mov_b32 v3, 162824
    s_add_u32 s29, s29, 1
Loth_79:
    ds_read_b32 v2, v3
    s_waitcnt lgkmcnt(0)
    v_cmp_gt_u32 vcc, s29, v2
    s_nop 4
    s_cbranch_vccnz Loth_79
    buffer_load_dwordx4 v[84:87], v4, s[12:15], s36 offen offset:0 sc1
    v_lshlrev_b32 v20, 16, v8
    v_and_b32 v21, 0xffff0000, v8
    v_lshlrev_b32 v22, 16, v9
    buffer_load_dwordx4 v[88:91], v4, s[12:15], s36 offen offset:2048 sc1
    s_add_u32 s36, s36, 4096
    v_and_b32 v23, 0xffff0000, v9
    v_lshlrev_b32 v24, 16, v10
    v_and_b32 v25, 0xffff0000, v10
    buffer_load_dwordx4 v[92:95], v4, s[12:15], s36 offen offset:0 sc1
    v_lshlrev_b32 v26, 16, v11
    v_and_b32 v27, 0xffff0000, v11
    v_lshlrev_b32 v28, 16, v12
    buffer_load_dwordx4 v[96:99], v4, s[12:15], s36 offen offset:2048 sc1
    s_add_u32 s36, s36, 4096
    v_and_b32 v29, 0xffff0000, v12
    v_lshlrev_b32 v30, 16, v13
    v_and_b32 v31, 0xffff0000, v13
    v_lshlrev_b32 v32, 16, v14
    buffer_load_dwordx4 v[100:103], v4, s[12:15], s36 offen offset:0 sc1
    v_and_b32 v33, 0xffff0000, v14
    v_lshlrev_b32 v34, 16, v15
    v_and_b32 v35, 0xffff0000, v15
    buffer_load_dwordx4 v[104:107], v4, s[12:15], s36 offen offset:2048 sc1
    s_add_u32 s36, s36, 4096
    s_lshl_b32 s30, s40, 15
    s_lshl_b32 s31, s43, 11
    s_add_u32 s30, s30, s31
    s_add_u32 s30, s30, s22
    s_add_u32 s30, s30, 0xa00000
    s_lshl_b32 s32, s40, 12
    s_lshr_b32 s31, s43, 2
    s_lshl_b32 s31, s31, 10
    s_add_u32 s32, s32, s31
    s_and_b32 s31, s43, 3
    s_lshl_b32 s31, s31, 2
    s_add_u32 s32, s32, s31
    s_add_u32 s32, s32, s22
    s_add_u32 s32, s32, 0x1280000
    buffer_load_dwordx4 v[108:111], v4, s[12:15], s36 offen offset:0 sc1
    s_lshr_b32 s33, s40, 2
    s_lshl_b32 s33, s33, 9
    s_bfe_u32 s31, s40, 0x10001
    s_lshl_b32 s31, s31, 8
    s_add_u32 s33, s33, s31
    s_lshl_b32 s31, s21, 3
    s_add_u32 s33, s33, s31
    s_lshl_b32 s31, s41, 5
    s_add_u32 s33, s33, s31
    s_add_u32 s33, s33, s22
    s_add_u32 s33, s33, 0x130c000
    s_mov_b32 s34, 0x3f803f80
    buffer_load_dwordx4 v[112:115], v4, s[12:15], s36 offen offset:2048 sc1
    s_add_u32 s36, s36, 4096
    s_xor_b32 s31, s21, 2
    s_lshl_b32 s31, s31, 12
    v_add_u32 v2, s31, v4
    s_lshl_b32 s31, s21, 12
    buffer_load_dwordx4 v[116:119], v4, s[12:15], s36 offen offset:0 sc1
    v_add_u32 v3, s31, v4
    ds_read_b64_tr_b16 v[52:53], v16 offset:0
    ds_read_b64_tr_b16 v[54:55], v16 offset:1024
    ds_read_b64_tr_b16 v[56:57], v17 offset:0
    ds_read_b64_tr_b16 v[58:59], v17 offset:1024
    buffer_load_dwordx4 v[120:123], v4, s[12:15], s36 offen offset:2048 sc1
    s_add_u32 s36, s36, 4096
    ds_read_b64_tr_b16 v[60:61], v16 offset:2048
    ds_read_b64_tr_b16 v[62:63], v16 offset:3072
    ds_read_b64_tr_b16 v[64:65], v17 offset:2048
    ds_read_b64_tr_b16 v[66:67], v17 offset:3072
    ds_read_b64_tr_b16 v[68:69], v16 offset:4096
    ds_read_b64_tr_b16 v[70:71], v16 offset:5120
    ds_read_b64_tr_b16 v[72:73], v17 offset:4096
    ds_read_b64_tr_b16 v[74:75], v17 offset:5120
    s_waitcnt vmcnt(9) lgkmcnt(8)
    v_mfma_f32_32x32x16_bf16 v[36:51], v[56:59], v[84:87], 0
    ds_read_b64_tr_b16 v[76:77], v16 offset:6144
    ds_read_b64_tr_b16 v[78:79], v16 offset:7168
    buffer_load_dwordx4 v[124:127], v4, s[12:15], s36 offen offset:0 sc1
    v_mfma_f32_32x32x16_bf16 v[20:35], v[52:55], v[84:87], v[20:35]
    ds_read_b64_tr_b16 v[80:81], v17 offset:6144
    ds_read_b64_tr_b16 v[82:83], v17 offset:7168
    s_waitcnt vmcnt(9) lgkmcnt(8)
    v_mfma_f32_32x32x16_bf16 v[36:51], v[64:67], v[88:91], v[36:51]
    ds_read_b64_tr_b16 v[52:53], v16 offset:8192
    ds_read_b64_tr_b16 v[54:55], v16 offset:9216
    buffer_load_dwordx4 v[128:131], v4, s[12:15], s36 offen offset:2048 sc1
    s_add_u32 s36, s36, 4096
    v_mfma_f32_32x32x16_bf16 v[20:35], v[60:63], v[88:91], v[20:35]
    ds_read_b64_tr_b16 v[56:57], v17 offset:8192
    ds_read_b64_tr_b16 v[58:59], v17 offset:9216
    s_waitcnt vmcnt(9) lgkmcnt(8)
    v_mfma_f32_32x32x16_bf16 v[36:51], v[72:75], v[92:95], v[36:51]
    ds_read_b64_tr_b16 v[60:61], v16 offset:10240
    ds_read_b64_tr_b16 v[62:63], v16 offset:11264
    buffer_load_dwordx4 v[132:135], v4, s[12:15], s36 offen offset:0 sc1
    v_mfma_f32_32x32x16_bf16 v[20:35], v[68:71], v[92:95], v[20:35]
    ds_read_b64_tr_b16 v[64:65], v17 offset:10240
    ds_read_b64_tr_b16 v[66:67], v17 offset:11264
    s_waitcnt vmcnt(9) lgkmcnt(8)
    v_mfma_f32_32x32x16_bf16 v[36:51], v[80:83], v[96:99], v[36:51]
    ds_read_b64_tr_b16 v[68:69], v16 offset:12288
    ds_read_b64_tr_b16 v[70:71], v16 offset:13312
    buffer_load_dwordx4 v[136:139], v4, s[12:15], s36 offen offset:2048 sc1
    s_add_u32 s36, s36, 4096
    v_mfma_f32_32x32x16_bf16 v[20:35], v[76:79], v[96:99], v[20:35]
    ds_read_b64_tr_b16 v[72:73], v17 offset:12288
    ds_read_b64_tr_b16 v[74:75], v17 offset:13312
    s_waitcnt vmcnt(9) lgkmcnt(8)
    v_mfma_f32_32x32x16_bf16 v[36:51], v[56:59], v[100:103], v[36:51]
    ds_read_b64_tr_b16 v[76:77], v16 offset:14336
    ds_read_b64_tr_b16 v[78:79], v16 offset:15360
    buffer_load_dwordx4 v[140:143], v4, s[12:15], s36 offen offset:0 sc1
    v_mfma_f32_32x32x16_bf16 v[20:35], v[52:55], v[100:103], v[20:35]
    ds_read_b64_tr_b16 v[80:81], v17 offset:14336
    ds_read_b64_tr_b16 v[82:83], v17 offset:15360
    s_waitcnt vmcnt(9) lgkmcnt(8)
    v_mfma_f32_32x32x16_bf16 v[36:51], v[64:67], v[104:107], v[36:51]
    ds_read_b64_tr_b16 v[52:53], v16 offset:16384
    ds_read_b64_tr_b16 v[54:55], v16 offset:17408
    buffer_load_dwordx4 v[144:147], v4, s[12:15], s36 offen offset:2048 sc1
    s_add_u32 s36, s36, 4096
    v_mfma_f32_32x32x16_bf16 v[20:35], v[60:63], v[104:107], v[20:35]
    ds_read_b64_tr_b16 v[56:57], v17 offset:16384
    ds_read_b64_tr_b16 v[58:59], v17 offset:17408
    s_waitcnt vmcnt(9) lgkmcnt(8)
    v_mfma_f32_32x32x16_bf16 v[36:51], v[72:75], v[108:111], v[36:51]
    ds_read_b64_tr_b16 v[60:61], v16 offset:18432
    ds_read_b64_tr_b16 v[62:63], v16 offset:19456
    buffer_load_dwordx4 v[148:151], v4, s[12:15], s36 offen offset:0 sc1
    v_mfma_f32_32x32x16_bf16 v[20:35], v[68:71], v[108:111], v[20:35]
    ds_read_b64_tr_b16 v[64:65], v17 offset:18432
    ds_read_b64_tr_b16 v[66:67], v17 offset:19456
    s_waitcnt vmcnt(9) lgkmcnt(8)
    v_mfma_f32_32x32x16_bf16 v[36:51], v[80:83], v[112:115], v[36:51]
    ds_read_b64_tr_b16 v[68:69], v16 offset:20480
    ds_read_b64_tr_b16 v[70:71], v16 offset:21504
    buffer_load_dwordx4 v[152:155], v4, s[12:15], s36 offen offset:2048 sc1
    s_add_u32 s36, s36, 4096
    v_mfma_f32_32x32x16_bf16 v[20:35], v[76:79], v[112:115], v[20:35]
    ds_read_b64_tr_b16 v[72:73], v17 offset:20480
    ds_read_b64_tr_b16 v[74:75], v17 offset:21504
    s_waitcnt vmcnt(9) lgkmcnt(8)
    v_mfma_f32_32x32x16_bf16 v[36:51], v[56:59], v[116:119], v[36:51]
    s_barrier
    ds_read_b64_tr_b16 v[76:77], v18 offset:0
    ds_read_b64_tr_b16 v[78:79], v18 offset:1024
    buffer_load_dwordx4 v[156:159], v4, s[12:15], s36 offen offset:0 sc1
    v_mfma_f32_32x32x16_bf16 v[20:35], v[52:55], v[116:119], v[20:35]
    ds_read_b64_tr_b16 v[80:81], v19 offset:0
    ds_read_b64_tr_b16 v[82:83], v19 offset:1024
    s_waitcnt vmcnt(9) lgkmcnt(8)
    v_mfma_f32_32x32x16_bf16 v[36:51], v[64:67], v[120:123], v[36:51]
    ds_read_b64_tr_b16 v[52:53], v18 offset:2048
    ds_read_b64_tr_b16 v[54:55], v18 offset:3072
    buffer_load_dwordx4 v[160:163], v4, s[12:15], s36 offen offset:2048 sc1
    s_add_u32 s36, s36, 4096
    v_mfma_f32_32x32x16_bf16 v[20:35], v[60:63], v[120:123], v[20:35]
    ds_read_b64_tr_b16 v[56:57], v19 offset:2048
    ds_read_b64_tr_b16 v[58:59], v19 offset:3072
    s_waitcnt vmcnt(9) lgkmcnt(8)
    v_mfma_f32_32x32x16_bf16 v[36:51], v[72:75], v[124:127], v[36:51]
    ds_read_b64_tr_b16 v[60:61], v18 offset:4096
    ds_read_b64_tr_b16 v[62:63], v18 offset:5120
    buffer_load_dwordx4 v[164:167], v4, s[12:15], s36 offen offset:0 sc1
    v_mfma_f32_32x32x16_bf16 v[20:35], v[68:71], v[124:127], v[20:35]
    ds_read_b64_tr_b16 v[64:65], v19 offset:4096
    ds_read_b64_tr_b16 v[66:67], v19 offset:5120
    s_waitcnt vmcnt(9) lgkmcnt(8)
    v_mfma_f32_32x32x16_bf16 v[36:51], v[80:83], v[128:131], v[36:51]
    ds_read_b64_tr_b16 v[68:69], v18 offset:6144
    ds_read_b64_tr_b16 v[70:71], v18 offset:7168
    buffer_load_dwordx4 v[168:171], v4, s[12:15], s36 offen offset:2048 sc1
    s_add_u32 s36, s36, 4096
    v_mfma_f32_32x32x16_bf16 v[20:35], v[76:79], v[128:131], v[20:35]
    ds_read_b64_tr_b16 v[72:73], v19 offset:6144
    ds_read_b64_tr_b16 v[74:75], v19 offset:7168
    s_waitcnt vmcnt(9) lgkmcnt(8)
    v_mfma_f32_32x32x16_bf16 v[36:51], v[56:59], v[132:135], v[36:51]
    ds_read_b64_tr_b16 v[76:77], v18 offset:8192
    ds_read_b64_tr_b16 v[78:79], v18 offset:9216
    buffer_load_dwordx4 v[172:175], v4, s[12:15], s36 offen offset:0 sc1
    v_mfma_f32_32x32x16_bf16 v[20:35], v[52:55], v[132:135], v[20:35]
    ds_read_b64_tr_b16 v[80:81], v19 offset:8192
    ds_read_b64_tr_b16 v[82:83], v19 offset:9216
    s_waitcnt vmcnt(9) lgkmcnt(8)
    v_mfma_f32_32x32x16_bf16 v[36:51], v[64:67], v[136:139], v[36:51]
    ds_read_b64_tr_b16 v[52:53], v18 offset:10240
    ds_read_b64_tr_b16 v[54:55], v18 offset:11264
    buffer_load_dwordx4 v[176:179], v4, s[12:15], s36 offen offset:2048 sc1
    s_add_u32 s36, s36, 4096
    v_mfma_f32_32x32x16_bf16 v[20:35], v[60:63], v[136:139], v[20:35]
    ds_read_b64_tr_b16 v[56:57], v19 offset:10240
    ds_read_b64_tr_b16 v[58:59], v19 offset:11264
    s_waitcnt vmcnt(9) lgkmcnt(8)
    v_mfma_f32_32x32x16_bf16 v[36:51], v[72:75], v[140:143], v[36:51]
    ds_read_b64_tr_b16 v[60:61], v18 offset:12288
    ds_read_b64_tr_b16 v[62:63], v18 offset:13312
    buffer_load_dwordx4 v[180:183], v4, s[12:15], s36 offen offset:0 sc1
    v_mfma_f32_32x32x16_bf16 v[20:35], v[68:71], v[140:143], v[20:35]
    ds_read_b64_tr_b16 v[64:65], v19 offset:12288
    ds_read_b64_tr_b16 v[66:67], v19 offset:13312
    s_waitcnt vmcnt(9) lgkmcnt(8)
    v_mfma_f32_32x32x16_bf16 v[36:51], v[80:83], v[144:147], v[36:51]
    ds_read_b64_tr_b16 v[68:69], v18 offset:14336
    ds_read_b64_tr_b16 v[70:71], v18 offset:15360
    buffer_load_dwordx4 v[184:187], v4, s[12:15], s36 offen offset:2048 sc1
    s_add_u32 s36, s36, 4096
    v_mfma_f32_32x32x16_bf16 v[20:35], v[76:79], v[144:147], v[20:35]
    ds_read_b64_tr_b16 v[72:73], v19 offset:14336
    ds_read_b64_tr_b16 v[74:75], v19 offset:15360
    s_waitcnt vmcnt(9) lgkmcnt(8)
    v_mfma_f32_32x32x16_bf16 v[36:51], v[56:59], v[148:151], v[36:51]
    ds_read_b64_tr_b16 v[76:77], v18 offset:16384
    ds_read_b64_tr_b16 v[78:79], v18 offset:17408
    buffer_load_dwordx4 v[188:191], v4, s[12:15], s36 offen offset:0 sc1
    v_mfma_f32_32x32x16_bf16 v[20:35], v[52:55], v[148:151], v[20:35]
    ds_read_b64_tr_b16 v[80:81], v19 offset:16384
    ds_read_b64_tr_b16 v[82:83], v19 offset:17408
    s_waitcnt vmcnt(9) lgkmcnt(8)
    v_mfma_f32_32x32x16_bf16 v[36:51], v[64:67], v[152:155], v[36:51]
    ds_read_b64_tr_b16 v[52:53], v18 offset:18432
    ds_read_b64_tr_b16 v[54:55], v18 offset:19456
    buffer_load_dwordx4 v[192:195], v4, s[12:15], s36 offen offset:2048 sc1
    s_add_u32 s36, s36, 4096
    v_mfma_f32_32x32x16_bf16 v[20:35], v[60:63], v[152:155], v[20:35]
    ds_read_b64_tr_b16 v[56:57], v19 offset:18432
    ds_read_b64_tr_b16 v[58:59], v19 offset:19456
    s_waitcnt vmcnt(9) lgkmcnt(8)
    v_mfma_f32_32x32x16_bf16 v[36:51], v[72:75], v[156:159], v[36:51]
    ds_read_b64_tr_b16 v[60:61], v18 offset:20480
    ds_read_b64_tr_b16 v[62:63], v18 offset:21504
    buffer_load_dwordx4 v[196:199], v4, s[12:15], s36 offen offset:0 sc1
    v_mfma_f32_32x32x16_bf16 v[20:35], v[68:71], v[156:159], v[20:35]
    ds_read_b64_tr_b16 v[64:65], v19 offset:20480
    ds_read_b64_tr_b16 v[66:67], v19 offset:21504
    s_waitcnt vmcnt(9) lgkmcnt(8)
    v_mfma_f32_32x32x16_bf16 v[36:51], v[80:83], v[160:163], v[36:51]
    ds_read_b64_tr_b16 v[68:69], v18 offset:22528
    ds_read_b64_tr_b16 v[70:71], v18 offset:23552
    buffer_load_dwordx4 v[200:203], v4, s[12:15], s36 offen offset:2048 sc1
    s_add_u32 s36, s36, 4096
    v_mfma_f32_32x32x16_bf16 v[20:35], v[76:79], v[160:163], v[20:35]
    ds_read_b64_tr_b16 v[72:73], v19 offset:22528
    ds_read_b64_tr_b16 v[74:75], v19 offset:23552
    s_waitcnt vmcnt(9) lgkmcnt(8)
    v_mfma_f32_32x32x16_bf16 v[36:51], v[56:59], v[164:167], v[36:51]
    ds_read_b64_tr_b16 v[76:77], v18 offset:24576
    ds_read_b64_tr_b16 v[78:79], v18 offset:25600
    buffer_load_dwordx4 v[204:207], v4, s[12:15], s36 offen offset:0 sc1
    v_mfma_f32_32x32x16_bf16 v[20:35], v[52:55], v[164:167], v[20:35]
    ds_read_b64_tr_b16 v[80:81], v19 offset:24576
    ds_read_b64_tr_b16 v[82:83], v19 offset:25600
    s_waitcnt vmcnt(9) lgkmcnt(8)
    v_mfma_f32_32x32x16_bf16 v[36:51], v[64:67], v[168:171], v[36:51]
    ds_read_b64_tr_b16 v[52:53], v18 offset:26624
    ds_read_b64_tr_b16 v[54:55], v18 offset:27648
    buffer_load_dwordx4 v[208:211], v4, s[12:15], s36 offen offset:2048 sc1
    s_add_u32 s36, s36, 4096
    v_mfma_f32_32x32x16_bf16 v[20:35], v[60:63], v[168:171], v[20:35]
    ds_read_b64_tr_b16 v[56:57], v19 offset:26624
    ds_read_b64_tr_b16 v[58:59], v19 offset:27648
    s_waitcnt vmcnt(9) lgkmcnt(8)
    v_mfma_f32_32x32x16_bf16 v[36:51], v[72:75], v[172:175], v[36:51]
    ds_read_b64_tr_b16 v[60:61], v18 offset:28672
    ds_read_b64_tr_b16 v[62:63], v18 offset:29696
    buffer_load_dwordx4 v[212:215], v4, s[12:15], s36 offen offset:0 sc1
    v_mfma_f32_32x32x16_bf16 v[20:35], v[68:71], v[172:175], v[20:35]
    ds_read_b64_tr_b16 v[64:65], v19 offset:28672
    ds_read_b64_tr_b16 v[66:67], v19 offset:29696
    s_waitcnt vmcnt(9) lgkmcnt(8)
    v_mfma_f32_32x32x16_bf16 v[36:51], v[80:83], v[176:179], v[36:51]
    ds_read_b64_tr_b16 v[68:69], v18 offset:30720
    ds_read_b64_tr_b16 v[70:71], v18 offset:31744
    buffer_load_dwordx4 v[216:219], v4, s[12:15], s36 offen offset:2048 sc1
    s_add_u32 s36, s36, 4096
    v_mfma_f32_32x32x16_bf16 v[20:35], v[76:79], v[176:179], v[20:35]
    ds_read_b64_tr_b16 v[72:73], v19 offset:30720
    ds_read_b64_tr_b16 v[74:75], v19 offset:31744
    s_waitcnt vmcnt(9) lgkmcnt(8)
    v_mfma_f32_32x32x16_bf16 v[36:51], v[56:59], v[180:183], v[36:51]
    ds_read_b64_tr_b16 v[76:77], v18 offset:32768
    ds_read_b64_tr_b16 v[78:79], v18 offset:33792
    buffer_load_dwordx4 v[220:223], v4, s[12:15], s36 offen offset:0 sc1
    v_mfma_f32_32x32x16_bf16 v[20:35], v[52:55], v[180:183], v[20:35]
    ds_read_b64_tr_b16 v[80:81], v19 offset:32768
    ds_read_b64_tr_b16 v[82:83], v19 offset:33792
    s_waitcnt vmcnt(9) lgkmcnt(8)
    v_mfma_f32_32x32x16_bf16 v[36:51], v[64:67], v[184:187], v[36:51]
    ds_read_b64_tr_b16 v[52:53], v18 offset:34816
    ds_read_b64_tr_b16 v[54:55], v18 offset:35840
    buffer_load_dwordx4 v[224:227], v4, s[12:15], s36 offen offset:2048 sc1
    s_add_u32 s36, s36, 4096
    v_mfma_f32_32x32x16_bf16 v[20:35], v[60:63], v[184:187], v[20:35]
    ds_read_b64_tr_b16 v[56:57], v19 offset:34816
    ds_read_b64_tr_b16 v[58:59], v19 offset:35840
    s_waitcnt vmcnt(9) lgkmcnt(8)
    v_mfma_f32_32x32x16_bf16 v[36:51], v[72:75], v[188:191], v[36:51]
    ds_read_b64_tr_b16 v[60:61], v18 offset:36864
    ds_read_b64_tr_b16 v[62:63], v18 offset:37888
    buffer_load_dwordx4 v[228:231], v4, s[12:15], s36 offen offset:0 sc1
    v_mfma_f32_32x32x16_bf16 v[20:35], v[68:71], v[188:191], v[20:35]
    ds_read_b64_tr_b16 v[64:65], v19 offset:36864
    ds_read_b64_tr_b16 v[66:67], v19 offset:37888
    s_waitcnt vmcnt(9) lgkmcnt(8)
    v_mfma_f32_32x32x16_bf16 v[36:51], v[80:83], v[192:195], v[36:51]
    ds_read_b64_tr_b16 v[68:69], v18 offset:38912
    ds_read_b64_tr_b16 v[70:71], v18 offset:39936
    buffer_load_dwordx4 v[232:235], v4, s[12:15], s36 offen offset:2048 sc1
    s_add_u32 s36, s36, 4096
    v_mfma_f32_32x32x16_bf16 v[20:35], v[76:79], v[192:195], v[20:35]
    ds_read_b64_tr_b16 v[72:73], v19 offset:38912
    ds_read_b64_tr_b16 v[74:75], v19 offset:39936
    s_waitcnt vmcnt(9) lgkmcnt(8)
    v_mfma_f32_32x32x16_bf16 v[36:51], v[56:59], v[196:199], v[36:51]
    ds_read_b64_tr_b16 v[76:77], v18 offset:40960
    ds_read_b64_tr_b16 v[78:79], v18 offset:41984
    buffer_load_dwordx4 v[236:239], v4, s[12:15], s36 offen offset:0 sc1
    v_mfma_f32_32x32x16_bf16 v[20:35], v[52:55], v[196:199], v[20:35]
    ds_read_b64_tr_b16 v[80:81], v19 offset:40960
    ds_read_b64_tr_b16 v[82:83], v19 offset:41984
    s_waitcnt vmcnt(9) lgkmcnt(8)
    v_mfma_f32_32x32x16_bf16 v[36:51], v[64:67], v[200:203], v[36:51]
    ds_read_b64_tr_b16 v[52:53], v18 offset:43008
    ds_read_b64_tr_b16 v[54:55], v18 offset:44032
    buffer_load_dwordx4 v[240:243], v4, s[12:15], s36 offen offset:2048 sc1
    s_add_u32 s36, s36, 4096
    v_mfma_f32_32x32x16_bf16 v[20:35], v[60:63], v[200:203], v[20:35]
    ds_read_b64_tr_b16 v[56:57], v19 offset:43008
    ds_read_b64_tr_b16 v[58:59], v19 offset:44032
    s_waitcnt vmcnt(9) lgkmcnt(8)
    v_mfma_f32_32x32x16_bf16 v[36:51], v[72:75], v[204:207], v[36:51]
    ds_read_b64_tr_b16 v[60:61], v18 offset:45056
    ds_read_b64_tr_b16 v[62:63], v18 offset:46080
    buffer_load_dwordx4 v[244:247], v4, s[12:15], s36 offen offset:0 sc1
    v_mfma_f32_32x32x16_bf16 v[20:35], v[68:71], v[204:207], v[20:35]
    ds_read_b64_tr_b16 v[64:65], v19 offset:45056
    ds_read_b64_tr_b16 v[66:67], v19 offset:46080
    s_waitcnt vmcnt(9) lgkmcnt(8)
    v_mfma_f32_32x32x16_bf16 v[36:51], v[80:83], v[208:211], v[36:51]
    ds_read_b64_tr_b16 v[68:69], v18 offset:47104
    ds_read_b64_tr_b16 v[70:71], v18 offset:48128
    buffer_load_dwordx4 v[248:251], v4, s[12:15], s36 offen offset:2048 sc1
    s_add_u32 s36, s36, 4096
    v_mfma_f32_32x32x16_bf16 v[20:35], v[76:79], v[208:211], v[20:35]
    ds_read_b64_tr_b16 v[72:73], v19 offset:47104
    ds_read_b64_tr_b16 v[74:75], v19 offset:48128
    s_waitcnt vmcnt(9) lgkmcnt(8)
    v_mfma_f32_32x32x16_bf16 v[36:51], v[56:59], v[212:215], v[36:51]
    s_barrier
    ds_read_b64_tr_b16 v[76:77], v16 offset:0
    ds_read_b64_tr_b16 v[78:79], v16 offset:1024
    buffer_load_dwordx4 v[252:255], v4, s[12:15], s36 offen offset:0 sc1
    v_mfma_f32_32x32x16_bf16 v[20:35], v[52:55], v[212:215], v[20:35]
    ds_read_b64_tr_b16 v[80:81], v17 offset:0
    ds_read_b64_tr_b16 v[82:83], v17 offset:1024
    s_waitcnt vmcnt(9) lgkmcnt(8)
    v_mfma_f32_32x32x16_bf16 v[36:51], v[64:67], v[216:219], v[36:51]
    ds_read_b64_tr_b16 v[52:53], v16 offset:2048
    ds_read_b64_tr_b16 v[54:55], v16 offset:3072
    v_mfma_f32_32x32x16_bf16 v[20:35], v[60:63], v[216:219], v[20:35]
    ds_read_b64_tr_b16 v[56:57], v17 offset:2048
    ds_read_b64_tr_b16 v[58:59], v17 offset:3072
    s_waitcnt vmcnt(8) lgkmcnt(8)
    v_mfma_f32_32x32x16_bf16 v[36:51], v[72:75], v[220:223], v[36:51]
    ds_read_b64_tr_b16 v[60:61], v16 offset:4096
    ds_read_b64_tr_b16 v[62:63], v16 offset:5120
    v_mfma_f32_32x32x16_bf16 v[20:35], v[68:71], v[220:223], v[20:35]
    ds_read_b64_tr_b16 v[64:65], v17 offset:4096
    ds_read_b64_tr_b16 v[66:67], v17 offset:5120
    s_waitcnt vmcnt(7) lgkmcnt(8)
    v_mfma_f32_32x32x16_bf16 v[36:51], v[80:83], v[224:227], v[36:51]
    ds_read_b64_tr_b16 v[68:69], v16 offset:6144
    ds_read_b64_tr_b16 v[70:71], v16 offset:7168
    v_mfma_f32_32x32x16_bf16 v[20:35], v[76:79], v[224:227], v[20:35]
    ds_read_b64_tr_b16 v[72:73], v17 offset:6144
    ds_read_b64_tr_b16 v[74:75], v17 offset:7168
    s_waitcnt vmcnt(6) lgkmcnt(8)
    v_mfma_f32_32x32x16_bf16 v[36:51], v[56:59], v[228:231], v[36:51]
    ds_read_b64_tr_b16 v[76:77], v16 offset:8192
    ds_read_b64_tr_b16 v[78:79], v16 offset:9216
    v_mfma_f32_32x32x16_bf16 v[20:35], v[52:55], v[228:231], v[20:35]
    ds_read_b64_tr_b16 v[80:81], v17 offset:8192
    ds_read_b64_tr_b16 v[82:83], v17 offset:9216
    s_waitcnt vmcnt(5) lgkmcnt(8)
    v_mfma_f32_32x32x16_bf16 v[36:51], v[64:67], v[232:235], v[36:51]
    ds_read_b64_tr_b16 v[52:53], v16 offset:10240
    ds_read_b64_tr_b16 v[54:55], v16 offset:11264
    v_mfma_f32_32x32x16_bf16 v[20:35], v[60:63], v[232:235], v[20:35]
    ds_read_b64_tr_b16 v[56:57], v17 offset:10240
    ds_read_b64_tr_b16 v[58:59], v17 offset:11264
    s_waitcnt vmcnt(4) lgkmcnt(8)
    v_mfma_f32_32x32x16_bf16 v[36:51], v[72:75], v[236:239], v[36:51]
    ds_read_b64_tr_b16 v[60:61], v16 offset:12288
    ds_read_b64_tr_b16 v[62:63], v16 offset:13312
    v_mfma_f32_32x32x16_bf16 v[20:35], v[68:71], v[236:239], v[20:35]
    ds_read_b64_tr_b16 v[64:65], v17 offset:12288
    ds_read_b64_tr_b16 v[66:67], v17 offset:13312
    s_waitcnt vmcnt(3) lgkmcnt(8)
    v_mfma_f32_32x32x16_bf16 v[36:51], v[80:83], v[240:243], v[36:51]
    ds_read_b64_tr_b16 v[68:69], v16 offset:14336
    ds_read_b64_tr_b16 v[70:71], v16 offset:15360
    ds_read_b64_tr_b16 v[72:73], v17 offset:14336
    ds_read_b64_tr_b16 v[74:75], v17 offset:15360
    s_waitcnt vmcnt(2) lgkmcnt(8)
    v_mfma_f32_32x32x16_bf16 v[36:51], v[56:59], v[244:247], v[36:51]
    s_waitcnt vmcnt(1) lgkmcnt(4)
    v_mfma_f32_32x32x16_bf16 v[36:51], v[64:67], v[248:251], v[36:51]
    s_waitcnt vmcnt(0) lgkmcnt(0)
    v_mfma_f32_32x32x16_bf16 v[36:51], v[72:75], v[252:255], v[36:51]
    v_mfma_f32_32x32x16_bf16 v[20:35], v[76:79], v[240:243], v[20:35]
    v_mfma_f32_32x32x16_bf16 v[20:35], v[52:55], v[244:247], v[20:35]
    v_mov_b32 v16, 0
    v_mov_b32 v17, 0
    s_nop 7
    ds_write_b128 v2, v[36:39] offset:0
    v_mfma_f32_32x32x16_bf16 v[20:35], v[60:63], v[248:251], v[20:35]
    ds_write_b128 v2, v[40:43] offset:1024
    v_mfma_f32_32x32x16_bf16 v[20:35], v[68:71], v[252:255], v[20:35]
    ds_write_b128 v2, v[44:47] offset:2048
    ds_write_b128 v2, v[48:51] offset:3072
    s_waitcnt lgkmcnt(0)
    s_barrier
    ds_read_b128 v[36:39], v3 offset:0
    ds_read_b128 v[40:43], v3 offset:1024
    ds_read_b128 v[44:47], v3 offset:2048
    ds_read_b128 v[48:51], v3 offset:3072
    s_cmp_lg_u32 s22, 0
    s_cbranch_scc1 mega_out
    s_waitcnt lgkmcnt(3)
    s_nop 0
    v_add_f32 v20, v20, v36
    v_add_f32 v21, v21, v37
    v_add_f32 v22, v22, v38
    v_add_f32 v23, v23, v39
    v_cvt_pk_bf16_f32 v8, v20, v21
    v_cvt_pk_bf16_f32 v9, v22, v23
    s_waitcnt lgkmcnt(2)
    v_add_f32 v24, v24, v40
    v_add_f32 v25, v25, v41
    v_add_f32 v26, v26, v42
    v_add_f32 v27, v27, v43
    v_cvt_pk_bf16_f32 v10, v24, v25
    v_cvt_pk_bf16_f32 v11, v26, v27
    s_waitcnt lgkmcnt(1)
    v_add_f32 v28, v28, v44
    v_add_f32 v29, v29, v45
    v_add_f32 v30, v30, v46
    v_add_f32 v31, v31, v47
    v_cvt_pk_bf16_f32 v12, v28, v29
    v_cvt_pk_bf16_f32 v13, v30, v31
    s_waitcnt lgkmcnt(0)
    v_add_f32 v32, v32, v48
    v_add_f32 v33, v33, v49
    v_add_f32 v34, v34, v50
    v_add_f32 v35, v35, v51
    v_cvt_pk_bf16_f32 v14, v32, v33
    v_cvt_pk_bf16_f32 v15, v34, v35
    v_dot2c_f32_bf16 v16, s34, v8
    v_dot2c_f32_bf16 v17, v8, v8
    v_dot2c_f32_bf16 v16, s34, v9
    v_dot2c_f32_bf16 v17, v9, v9
    s_cmp_eq_u32 s3, 0
    s_cbranch_scc1 Lss_80
    buffer_store_dwordx4 v[8:11], v4, s[12:15], s30 offen
Lsd_81:
    v_dot2c_f32_bf16 v16, s34, v10
    v_dot2c_f32_bf16 v17, v10, v10
    v_dot2c_f32_bf16 v16, s34, v11
    v_dot2c_f32_bf16 v17, v11, v11
    v_dot2c_f32_bf16 v16, s34, v12
    v_dot2c_f32_bf16 v17, v12, v12
    s_cmp_eq_u32 s3, 0
    s_cbranch_scc1 Lss_82
    buffer_store_dwordx4 v[12:15], v4, s[12:15], s30 offen offset:1024
Lsd_83:
    v_dot2c_f32_bf16 v16, s34, v13
    v_dot2c_f32_bf16 v17, v13, v13
    v_dot2c_f32_bf16 v16, s34, v14
    v_dot2c_f32_bf16 v17, v14, v14
    v_dot2c_f32_bf16 v16, s34, v15
    v_dot2c_f32_bf16 v17, v15, v15
    s_nop 2
    v_permlane32_swap_b32 v16, v17
    v_add_f32 v16, v16, v17
    s_cmp_eq_u32 s3, 0
    s_cbranch_scc1 Lss_84
    buffer_store_dword v16, v4, s[12:15], s32 offen
Lsd_85:
    v_bfe_u32 v2, v1, 2, 2
    v_lshl_add_u32 v2, v5, 2, v2
    v_mul_u32_u24 v2, 192, v2
    v_bfe_u32 v3, v1, 4, 1
    v_lshl_add_u32 v2, v3, 5, v2
    v_and_b32 v3, 3, v1
    v_lshl_add_u32 v16, v3, 3, v2
    v_add_u32 v16, 64512, v16
    v_add_u32 v17, 49152, v16
    s_mul_i32 s30, s21, 2304
    s_add_u32 s30, s30, 16384
    v_bfe_u32 v2, v1, 2, 2
    v_lshl_add_u32 v2, v5, 2, v2
    v_mul_u32_u24 v2, 72, v2
    v_bfe_u32 v3, v1, 4, 1
    v_lshl_add_u32 v2, v3, 5, v2
    v_and_b32 v3, 3, v1
    v_lshl_add_u32 v19, v3, 3, v2
    v_add_u32 v19, s30, v19
    v_and_b32 v2, 31, v1
    v_mul_u32_u24 v2, 72, v2
    v_lshl_add_u32 v2, v5, 3, v2
    v_add_u32 v18, s30, v2
    v_bfe_u32 v2, v1, 4, 1
    v_lshlrev_b32 v2, 16, v2
    v_lshl_add_u32 v2, v5, 8, v2
    v_and_b32 v3, 15, v1
    v_lshl_add_u32 v20, v3, 4, v2
    s_lshl_b32 s36, s92, 15
    s_add_u32 s36, s36, s22
    s_add_u32 s36, s36, 0xa00000
    s_lshl_b32 s37, s92, 12
    s_add_u32 s37, s37, s22
    s_add_u32 s37, s37, 0x1280000
    v_mov_b32 v2, s8
    v_mov_b32 v3, s9
    v_mov_b32 v7, 0
    s_mov_b64 exec, 1
    s_waitcnt vmcnt(0)
    s_cmp_eq_u32 s3, 0
    s_cbranch_scc1 Lss_86
    buffer_store_dwordx2 v[2:3], v7, s[12:15], s33 offen
Lsd_87:
    s_mov_b64 exec, -1
    v_mov_b32 v3, 162824
    s_add_u32 s29, s29, 1
Loth_88:
    ds_read_b32 v2, v3
    s_waitcnt lgkmcnt(0)
    v_cmp_gt_u32 vcc, s29, v2
    s_nop 4
    s_cbranch_vccnz Loth_88
    buffer_load_dwordx4 v[128:131], v4, s[12:15], s36 offen offset:0 sc1
    buffer_load_dwordx4 v[132:135], v4, s[12:15], s36 offen offset:1024 sc1
    buffer_load_dwordx4 v[136:139], v4, s[12:15], s36 offen offset:2048 sc1
    buffer_load_dwordx4 v[140:143], v4, s[12:15], s36 offen offset:3072 sc1
    s_add_u32 s36, s36, 4096
    buffer_load_dwordx4 v[112:115], v4, s[12:15], s37 offen offset:0 sc1
    buffer_load_dwordx4 v[116:119], v4, s[12:15], s37 offen offset:1024 sc1
    buffer_load_dwordx4 v[120:123], v4, s[12:15], s37 offen offset:2048 sc1
    buffer_load_dwordx4 v[124:127], v4, s[12:15], s37 offen offset:3072 sc1
    buffer_load_dwordx4 v[144:147], v4, s[12:15], s36 offen offset:0 sc1
    buffer_load_dwordx4 v[148:151], v4, s[12:15], s36 offen offset:1024 sc1
    s_barrier
    ds_read_b64_tr_b16 v[28:29], v16 offset:0
    ds_read_b64_tr_b16 v[30:31], v16 offset:1536
    ds_read_b64_tr_b16 v[32:33], v16 offset:64
    ds_read_b64_tr_b16 v[34:35], v16 offset:1600
    ds_read_b64_tr_b16 v[36:37], v16 offset:128
    ds_read_b64_tr_b16 v[38:39], v16 offset:1664
    ds_read_b64_tr_b16 v[40:41], v16 offset:3072
    ds_read_b64_tr_b16 v[42:43], v16 offset:4608
    ds_read_b64_tr_b16 v[44:45], v16 offset:3136
    ds_read_b64_tr_b16 v[46:47], v16 offset:4672
    ds_read_b64_tr_b16 v[48:49], v16 offset:3200
    ds_read_b64_tr_b16 v[50:51], v16 offset:4736
    s_waitcnt vmcnt(9) lgkmcnt(6)
    v_mfma_f32_32x32x16_bf16 v[64:79], v[28:31], v[128:131], 0
    ds_read_b64_tr_b16 v[52:53], v16 offset:6144
    ds_read_b64_tr_b16 v[54:55], v16 offset:7680
    buffer_load_dwordx4 v[152:155], v4, s[12:15], s36 offen offset:2048 sc1
    v_mfma_f32_32x32x16_bf16 v[80:95], v[32:35], v[128:131], 0
    ds_read_b64_tr_b16 v[56:57], v16 offset:6208
    ds_read_b64_tr_b16 v[58:59], v16 offset:7744
    buffer_load_dwordx4 v[156:159], v4, s[12:15], s36 offen offset:3072 sc1
    s_add_u32 s36, s36, 4096
    v_mfma_f32_32x32x16_bf16 v[96:111], v[36:39], v[128:131], 0
    ds_read_b64_tr_b16 v[60:61], v16 offset:6272
    ds_read_b64_tr_b16 v[62:63], v16 offset:7808
    s_waitcnt vmcnt(10) lgkmcnt(6)
    v_mfma_f32_32x32x16_bf16 v[64:79], v[40:43], v[132:135], v[64:79]
    ds_read_b64_tr_b16 v[28:29], v16 offset:9216
    ds_read_b64_tr_b16 v[30:31], v16 offset:10752
    buffer_load_dwordx4 v[160:163], v4, s[12:15], s36 offen offset:0 sc1
    v_mfma_f32_32x32x16_bf16 v[80:95], v[44:47], v[132:135], v[80:95]
    ds_read_b64_tr_b16 v[32:33], v16 offset:9280
    ds_read_b64_tr_b16 v[34:35], v16 offset:10816
    buffer_load_dwordx4 v[164:167], v4, s[12:15], s36 offen offset:1024 sc1
    v_mfma_f32_32x32x16_bf16 v[96:111], v[48:51], v[132:135], v[96:111]
    ds_read_b64_tr_b16 v[36:37], v16 offset:9344
    ds_read_b64_tr_b16 v[38:39], v16 offset:10880
    s_waitcnt vmcnt(11) lgkmcnt(6)
    v_mfma_f32_32x32x16_bf16 v[64:79], v[52:55], v[136:139], v[64:79]
    ds_read_b64_tr_b16 v[40:41], v16 offset:12288
    ds_read_b64_tr_b16 v[42:43], v16 offset:13824
    buffer_load_dwordx4 v[168:171], v4, s[12:15], s36 offen offset:2048 sc1
    v_mfma_f32_32x32x16_bf16 v[80:95], v[56:59], v[136:139], v[80:95]
    ds_read_b64_tr_b16 v[44:45], v16 offset:12352
    ds_read_b64_tr_b16 v[46:47], v16 offset:13888
    buffer_load_dwordx4 v[172:175], v4, s[12:15], s36 offen offset:3072 sc1
    s_add_u32 s36, s36, 4096
    v_mfma_f32_32x32x16_bf16 v[96:111], v[60:63], v[136:139], v[96:111]
    ds_read_b64_tr_b16 v[48:49], v16 offset:12416
    ds_read_b64_tr_b16 v[50:51], v16 offset:13952
    s_waitcnt vmcnt(12) lgkmcnt(6)
    v_mfma_f32_32x32x16_bf16 v[64:79], v[28:31], v[140:143], v[64:79]
    ds_read_b64_tr_b16 v[52:53], v16 offset:15360
    ds_read_b64_tr_b16 v[54:55], v16 offset:16896
    buffer_load_dwordx4 v[176:179], v4, s[12:15], s36 offen offset:0 sc1
    v_mfma_f32_32x32x16_bf16 v[80:95], v[32:35], v[140:143], v[80:95]
    ds_read_b64_tr_b16 v[56:57], v16 offset:15424
    ds_read_b64_tr_b16 v[58:59], v16 offset:16960
    buffer_load_dwordx4 v[180:183], v4, s[12:15], s36 offen offset:1024 sc1
    v_mfma_f32_32x32x16_bf16 v[96:111], v[36:39], v[140:143], v[96:111]
    ds_read_b64_tr_b16 v[60:61], v16 offset:15488
    ds_read_b64_tr_b16 v[62:63], v16 offset:17024
    s_waitcnt vmcnt(9) lgkmcnt(6)
    v_mfma_f32_32x32x16_bf16 v[64:79], v[40:43], v[144:147], v[64:79]
    ds_read_b64_tr_b16 v[28:29], v16 offset:18432
    ds_read_b64_tr_b16 v[30:31], v16 offset:19968
    buffer_load_dwordx4 v[184:187], v4, s[12:15], s36 offen offset:2048 sc1
    v_mfma_f32_32x32x16_bf16 v[80:95], v[44:47], v[144:147], v[80:95]
    ds_read_b64_tr_b16 v[32:33], v16 offset:18496
    ds_read_b64_tr_b16 v[34:35], v16 offset:20032
    v_mfma_f32_32x32x16_bf16 v[96:111], v[48:51], v[144:147], v[96:111]
    ds_read_b64_tr_b16 v[36:37], v16 offset:18560
    ds_read_b64_tr_b16 v[38:39], v16 offset:20096
    s_waitcnt vmcnt(9) lgkmcnt(6)
    v_mfma_f32_32x32x16_bf16 v[64:79], v[52:55], v[148:151], v[64:79]
    ds_read_b64_tr_b16 v[40:41], v16 offset:21504
    ds_read_b64_tr_b16 v[42:43], v16 offset:23040
    buffer_load_dwordx4 v[188:191], v4, s[12:15], s36 offen offset:3072 sc1
    s_add_u32 s36, s36, 4096
    v_mfma_f32_32x32x16_bf16 v[80:95], v[56:59], v[148:151], v[80:95]
    ds_read_b64_tr_b16 v[44:45], v16 offset:21568
    ds_read_b64_tr_b16 v[46:47], v16 offset:23104
    v_mfma_f32_32x32x16_bf16 v[96:111], v[60:63], v[148:151], v[96:111]
    ds_read_b64_tr_b16 v[48:49], v16 offset:21632
    ds_read_b64_tr_b16 v[50:51], v16 offset:23168
    s_waitcnt vmcnt(9) lgkmcnt(6)
    v_mfma_f32_32x32x16_bf16 v[64:79], v[28:31], v[152:155], v[64:79]
    ds_read_b64_tr_b16 v[52:53], v16 offset:24576
    ds_read_b64_tr_b16 v[54:55], v16 offset:26112
    buffer_load_dwordx4 v[192:195], v4, s[12:15], s36 offen offset:0 sc1
    v_mfma_f32_32x32x16_bf16 v[80:95], v[32:35], v[152:155], v[80:95]
    ds_read_b64_tr_b16 v[56:57], v16 offset:24640
    ds_read_b64_tr_b16 v[58:59], v16 offset:26176
    v_mfma_f32_32x32x16_bf16 v[96:111], v[36:39], v[152:155], v[96:111]
    ds_read_b64_tr_b16 v[60:61], v16 offset:24704
    ds_read_b64_tr_b16 v[62:63], v16 offset:26240
    s_waitcnt vmcnt(9) lgkmcnt(6)
    v_mfma_f32_32x32x16_bf16 v[64:79], v[40:43], v[156:159], v[64:79]
    ds_read_b64_tr_b16 v[28:29], v16 offset:27648
    ds_read_b64_tr_b16 v[30:31], v16 offset:29184
    buffer_load_dwordx4 v[196:199], v4, s[12:15], s36 offen offset:1024 sc1
    v_mfma_f32_32x32x16_bf16 v[80:95], v[44:47], v[156:159], v[80:95]
    ds_read_b64_tr_b16 v[32:33], v16 offset:27712
    ds_read_b64_tr_b16 v[34:35], v16 offset:29248
    v_mfma_f32_32x32x16_bf16 v[96:111], v[48:51], v[156:159], v[96:111]
    ds_read_b64_tr_b16 v[36:37], v16 offset:27776
    ds_read_b64_tr_b16 v[38:39], v16 offset:29312
    s_waitcnt vmcnt(9) lgkmcnt(6)
    v_mfma_f32_32x32x16_bf16 v[64:79], v[52:55], v[160:163], v[64:79]
    ds_read_b64_tr_b16 v[40:41], v16 offset:30720
    ds_read_b64_tr_b16 v[42:43], v16 offset:32256
    buffer_load_dwordx4 v[200:203], v4, s[12:15], s36 offen offset:2048 sc1
    v_add_f32 v112, v112, v114
    v_mfma_f32_32x32x16_bf16 v[80:95], v[56:59], v[160:163], v[80:95]
    ds_read_b64_tr_b16 v[44:45], v16 offset:30784
    ds_read_b64_tr_b16 v[46:47], v16 offset:32320
    v_add_f32 v113, v113, v115
    v_mfma_f32_32x32x16_bf16 v[96:111], v[60:63], v[160:163], v[96:111]
    ds_read_b64_tr_b16 v[48:49], v16 offset:30848
    ds_read_b64_tr_b16 v[50:51], v16 offset:32384
    v_add_f32 v112, v112, v116
    s_waitcnt vmcnt(9) lgkmcnt(6)
    v_mfma_f32_32x32x16_bf16 v[64:79], v[28:31], v[164:167], v[64:79]
    ds_read_b64_tr_b16 v[52:53], v16 offset:33792
    ds_read_b64_tr_b16 v[54:55], v16 offset:35328
    buffer_load_dwordx4 v[204:207], v4, s[12:15], s36 offen offset:3072 sc1
    s_add_u32 s36, s36, 4096
    v_add_f32 v113, v113, v117
    v_mfma_f32_32x32x16_bf16 v[80:95], v[32:35], v[164:167], v[80:95]
    ds_read_b64_tr_b16 v[56:57], v16 offset:33856
    ds_read_b64_tr_b16 v[58:59], v16 offset:35392
    v_add_f32 v112, v112, v118
    v_mfma_f32_32x32x16_bf16 v[96:111], v[36:39], v[164:167], v[96:111]
    ds_read_b64_tr_b16 v[60:61], v16 offset:33920
    ds_read_b64_tr_b16 v[62:63], v16 offset:35456
    v_add_f32 v113, v113, v119
    s_waitcnt vmcnt(9) lgkmcnt(6)
    v_mfma_f32_32x32x16_bf16 v[64:79], v[40:43], v[168:171], v[64:79]
    ds_read_b64_tr_b16 v[28:29], v16 offset:36864
    ds_read_b64_tr_b16 v[30:31], v16 offset:38400
    buffer_load_dwordx4 v[208:211], v4, s[12:15], s36 offen offset:0 sc1
    v_add_f32 v112, v112, v120
    v_mfma_f32_32x32x16_bf16 v[80:95], v[44:47], v[168:171], v[80:95]
    ds_read_b64_tr_b16 v[32:33], v16 offset:36928
    ds_read_b64_tr_b16 v[34:35], v16 offset:38464
    v_add_f32 v113, v113, v121
    v_mfma_f32_32x32x16_bf16 v[96:111], v[48:51], v[168:171], v[96:111]
    ds_read_b64_tr_b16 v[36:37], v16 offset:36992
    ds_read_b64_tr_b16 v[38:39], v16 offset:38528
    v_add_f32 v112, v112, v122
    s_waitcnt vmcnt(9) lgkmcnt(6)
    v_mfma_f32_32x32x16_bf16 v[64:79], v[52:55], v[172:175], v[64:79]
    ds_read_b64_tr_b16 v[40:41], v16 offset:39936
    ds_read_b64_tr_b16 v[42:43], v16 offset:41472
    buffer_load_dwordx4 v[212:215], v4, s[12:15], s36 offen offset:1024 sc1
    v_add_f32 v113, v113, v123
    v_mfma_f32_32x32x16_bf16 v[80:95], v[56:59], v[172:175], v[80:95]
    ds_read_b64_tr_b16 v[44:45], v16 offset:40000
    ds_read_b64_tr_b16 v[46:47], v16 offset:41536
    v_add_f32 v112, v112, v124
    v_mfma_f32_32x32x16_bf16 v[96:111], v[60:63], v[172:175], v[96:111]
    ds_read_b64_tr_b16 v[48:49], v16 offset:40064
    ds_read_b64_tr_b16 v[50:51], v16 offset:41600
    v_add_f32 v113, v113, v125
    s_waitcnt vmcnt(9) lgkmcnt(6)
    v_mfma_f32_32x32x16_bf16 v[64:79], v[28:31], v[176:179], v[64:79]
    ds_read_b64_tr_b16 v[52:53], v16 offset:43008
    ds_read_b64_tr_b16 v[54:55], v16 offset:44544
    buffer_load_dwordx4 v[216:219], v4, s[12:15], s36 offen offset:2048 sc1
    v_add_f32 v112, v112, v126
    v_mfma_f32_32x32x16_bf16 v[80:95], v[32:35], v[176:179], v[80:95]
    ds_read_b64_tr_b16 v[56:57], v16 offset:43072
    ds_read_b64_tr_b16 v[58:59], v16 offset:44608
    v_add_f32 v113, v113, v127
    v_mfma_f32_32x32x16_bf16 v[96:111], v[36:39], v[176:179], v[96:111]
    ds_read_b64_tr_b16 v[60:61], v16 offset:43136
    ds_read_b64_tr_b16 v[62:63], v16 offset:44672
    v_add_f32 v112, v112, v113
    s_waitcnt vmcnt(9) lgkmcnt(6)
    v_mfma_f32_32x32x16_bf16 v[64:79], v[40:43], v[180:183], v[64:79]
    ds_read_b64_tr_b16 v[28:29], v16 offset:46080
    ds_read_b64_tr_b16 v[30:31], v16 offset:47616
    buffer_load_dwordx4 v[220:223], v4, s[12:15], s36 offen offset:3072 sc1
    s_add_u32 s36, s36, 4096
    v_mov_b32 v113, v112
    v_mfma_f32_32x32x16_bf16 v[80:95], v[44:47], v[180:183], v[80:95]
    ds_read_b64_tr_b16 v[32:33], v16 offset:46144
    ds_read_b64_tr_b16 v[34:35], v16 offset:47680
    s_nop 0
    v_mfma_f32_32x32x16_bf16 v[96:111], v[48:51], v[180:183], v[96:111]
    ds_read_b64_tr_b16 v[36:37], v16 offset:46208
    ds_read_b64_tr_b16 v[38:39], v16 offset:47744
    v_permlane32_swap_b32 v112, v113
    s_waitcnt vmcnt(9) lgkmcnt(6)
    v_mfma_f32_32x32x16_bf16 v[64:79], v[52:55], v[184:187], v[64:79]
    ds_read_b64_tr_b16 v[40:41], v17 offset:0
    ds_read_b64_tr_b16 v[42:43], v17 offset:1536
    buffer_load_dwordx4 v[224:227], v4, s[12:15], s36 offen offset:0 sc1
    v_mul_f32 v112, 0xbb000000, v112
    v_mfma_f32_32x32x16_bf16 v[80:95], v[56:59], v[184:187], v[80:95]
    ds_read_b64_tr_b16 v[44:45], v17 offset:64
    ds_read_b64_tr_b16 v[46:47], v17 offset:1600
    v_mul_f32 v113, 0x3b000000, v113
    v_mfma_f32_32x32x16_bf16 v[96:111], v[60:63], v[184:187], v[96:111]
    ds_read_b64_tr_b16 v[48:49], v17 offset:128
    ds_read_b64_tr_b16 v[50:51], v17 offset:1664
    v_fma_f32 v113, -v112, v112, v113
    s_waitcnt vmcnt(9) lgkmcnt(6)
    v_mfma_f32_32x32x16_bf16 v[64:79], v[28:31], v[188:191], v[64:79]
    ds_read_b64_tr_b16 v[52:53], v17 offset:3072
    ds_read_b64_tr_b16 v[54:55], v17 offset:4608
    buffer_load_dwordx4 v[228:231], v4, s[12:15], s36 offen offset:1024 sc1
    v_max_f32 v113, 0, v113
    v_mfma_f32_32x32x16_bf16 v[80:95], v[32:35], v[188:191], v[80:95]
    ds_read_b64_tr_b16 v[56:57], v17 offset:3136
    ds_read_b64_tr_b16 v[58:59], v17 offset:4672
    v_add_f32 v113, 0x3727c5ac, v113
    v_mfma_f32_32x32x16_bf16 v[96:111], v[36:39], v[188:191], v[96:111]
    ds_read_b64_tr_b16 v[60:61], v17 offset:3200
    ds_read_b64_tr_b16 v[62:63], v17 offset:4736
    v_rsq_f32 v21, v113
    s_waitcnt vmcnt(9) lgkmcnt(6)
    v_mfma_f32_32x32x16_bf16 v[64:79], v[40:43], v[192:195], v[64:79]
    ds_read_b64_tr_b16 v[28:29], v17 offset:6144
    ds_read_b64_tr_b16 v[30:31], v17 offset:7680
    buffer_load_dwordx4 v[232:235], v4, s[12:15], s36 offen offset:2048 sc1
    v_cvt_pk_bf16_f32 v24, v112, v112
    v_mfma_f32_32x32x16_bf16 v[80:95], v[44:47], v[192:195], v[80:95]
    ds_read_b64_tr_b16 v[32:33], v17 offset:6208
    ds_read_b64_tr_b16 v[34:35], v17 offset:7744
    v_mul_f32 v22, v113, v21
    v_mfma_f32_32x32x16_bf16 v[96:111], v[48:51], v[192:195], v[96:111]
    ds_read_b64_tr_b16 v[36:37], v17 offset:6272
    ds_read_b64_tr_b16 v[38:39], v17 offset:7808
    v_and_b32 v25, 0xffff0000, v24
    s_waitcnt vmcnt(9) lgkmcnt(6)
    v_mfma_f32_32x32x16_bf16 v[64:79], v[52:55], v[196:199], v[64:79]
    ds_read_b64_tr_b16 v[40:41], v17 offset:9216
    ds_read_b64_tr_b16 v[42:43], v17 offset:10752
    buffer_load_dwordx4 v[236:239], v4, s[12:15], s36 offen offset:3072 sc1
    s_add_u32 s36, s36, 4096
    v_sub_f32 v112, v112, v25
    v_mfma_f32_32x32x16_bf16 v[80:95], v[56:59], v[196:199], v[80:95]
    ds_read_b64_tr_b16 v[44:45], v17 offset:9280
    ds_read_b64_tr_b16 v[46:47], v17 offset:10816
    v_cvt_pk_bf16_f32 v24, v25, v112
    v_mfma_f32_32x32x16_bf16 v[96:111], v[60:63], v[196:199], v[96:111]
    ds_read_b64_tr_b16 v[48:49], v17 offset:9344
    ds_read_b64_tr_b16 v[50:51], v17 offset:10880
    v_cvt_pk_bf16_f32 v27, v25, v22
    s_waitcnt vmcnt(9) lgkmcnt(6)
    v_mfma_f32_32x32x16_bf16 v[64:79], v[28:31], v[200:203], v[64:79]
    ds_read_b64_tr_b16 v[52:53], v17 offset:12288
    ds_read_b64_tr_b16 v[54:55], v17 offset:13824
    buffer_load_dwordx4 v[240:243], v4, s[12:15], s36 offen offset:0 sc1
    v_and_b32 v112, 0xffff0000, v27
    v_mfma_f32_32x32x16_bf16 v[80:95], v[32:35], v[200:203], v[80:95]
    ds_read_b64_tr_b16 v[56:57], v17 offset:12352
    ds_read_b64_tr_b16 v[58:59], v17 offset:13888
    v_sub_f32 v112, v22, v112
    v_mfma_f32_32x32x16_bf16 v[96:111], v[36:39], v[200:203], v[96:111]
    ds_read_b64_tr_b16 v[60:61], v17 offset:12416
    ds_read_b64_tr_b16 v[62:63], v17 offset:13952
    v_cvt_pk_bf16_f32 v26, v25, v112
    s_waitcnt vmcnt(9) lgkmcnt(6)
    v_mfma_f32_32x32x16_bf16 v[64:79], v[40:43], v[204:207], v[64:79]
    ds_read_b64_tr_b16 v[28:29], v17 offset:15360
    ds_read_b64_tr_b16 v[30:31], v17 offset:16896
    buffer_load_dwordx4 v[244:247], v4, s[12:15], s36 offen offset:1024 sc1
    v_and_b32 v113, 0xffff0000, v26
    v_mfma_f32_32x32x16_bf16 v[80:95], v[44:47], v[204:207], v[80:95]
    ds_read_b64_tr_b16 v[32:33], v17 offset:15424
    ds_read_b64_tr_b16 v[34:35], v17 offset:16960
    v_sub_f32 v113, v112, v113
    v_mfma_f32_32x32x16_bf16 v[96:111], v[48:51], v[204:207], v[96:111]
    ds_read_b64_tr_b16 v[36:37], v17 offset:15488
    ds_read_b64_tr_b16 v[38:39], v17 offset:17024
    v_cvt_pk_bf16_f32 v113, v25, v113
    s_waitcnt vmcnt(9) lgkmcnt(6)
    v_mfma_f32_32x32x16_bf16 v[64:79], v[52:55], v[208:211], v[64:79]
    ds_read_b64_tr_b16 v[40:41], v17 offset:18432
    ds_read_b64_tr_b16 v[42:43], v17 offset:19968
    buffer_load_dwordx4 v[248:251], v4, s[12:15], s36 offen offset:2048 sc1
    v_cmp_eq_u32 vcc, 0, v5
    v_mfma_f32_32x32x16_bf16 v[80:95], v[56:59], v[208:211], v[80:95]
    ds_read_b64_tr_b16 v[44:45], v17 offset:18496
    ds_read_b64_tr_b16 v[46:47], v17 offset:20032
    v_cndmask_b32 v25, v113, v27, vcc
    v_mfma_f32_32x32x16_bf16 v[96:111], v[60:63], v[208:211], v[96:111]
    ds_read_b64_tr_b16 v[48:49], v17 offset:18560
    ds_read_b64_tr_b16 v[50:51], v17 offset:20096
    v_mov_b32 v27, v26
    s_waitcnt vmcnt(9) lgkmcnt(6)
    v_mfma_f32_32x32x16_bf16 v[64:79], v[28:31], v[212:215], v[64:79]
    ds_read_b64_tr_b16 v[52:53], v17 offset:21504
    ds_read_b64_tr_b16 v[54:55], v17 offset:23040
    buffer_load_dwordx4 v[252:255], v4, s[12:15], s36 offen offset:3072 sc1
    s_add_u32 s36, s36, 4096
    v_mov_b32 v26, v24
    v_mfma_f32_32x32x16_bf16 v[80:95], v[32:35], v[212:215], v[80:95]
    ds_read_b64_tr_b16 v[56:57], v17 offset:21568
    ds_read_b64_tr_b16 v[58:59], v17 offset:23104
    s_add_u32 s38, s22, 0x2000000
    v_mfma_f32_32x32x16_bf16 v[96:111], v[36:39], v[212:215], v[96:111]
    ds_read_b64_tr_b16 v[60:61], v17 offset:21632
    ds_read_b64_tr_b16 v[62:63], v17 offset:23168
    s_lshl_b32 s39, s93, 9
    s_and_b32 s31, s92, 0x3c
    s_lshl_b32 s31, s31, 1
    s_add_u32 s39, s39, s31
    s_add_u32 s39, s39, s38
    s_add_u32 s39, s39, 0x1300000
    s_waitcnt vmcnt(9) lgkmcnt(6)
    v_mfma_f32_32x32x16_bf16 v[64:79], v[40:43], v[216:219], v[64:79]
    ds_read_b64_tr_b16 v[28:29], v17 offset:24576
    ds_read_b64_tr_b16 v[30:31], v17 offset:26112
    v_mfma_f32_32x32x16_bf16 v[80:95], v[44:47], v[216:219], v[80:95]
    ds_read_b64_tr_b16 v[32:33], v17 offset:24640
    ds_read_b64_tr_b16 v[34:35], v17 offset:26176
    v_mfma_f32_32x32x16_bf16 v[96:111], v[48:51], v[216:219], v[96:111]
    ds_read_b64_tr_b16 v[36:37], v17 offset:24704
    ds_read_b64_tr_b16 v[38:39], v17 offset:26240
    s_waitcnt vmcnt(8) lgkmcnt(6)
    v_mfma_f32_32x32x16_bf16 v[64:79], v[52:55], v[220:223], v[64:79]
    ds_read_b64_tr_b16 v[40:41], v17 offset:27648
    ds_read_b64_tr_b16 v[42:43], v17 offset:29184
    v_mfma_f32_32x32x16_bf16 v[80:95], v[56:59], v[220:223], v[80:95]
    ds_read_b64_tr_b16 v[44:45], v17 offset:30720
    ds_read_b64_tr_b16 v[46:47], v17 offset:32256
    v_mfma_f32_32x32x16_bf16 v[96:111], v[60:63], v[220:223], v[96:111]
    ds_read_b64_tr_b16 v[48:49], v17 offset:33792
    ds_read_b64_tr_b16 v[50:51], v17 offset:35328
    s_waitcnt vmcnt(7) lgkmcnt(6)
    v_mfma_f32_32x32x16_bf16 v[64:79], v[28:31], v[224:227], v[64:79]
    ds_read_b64_tr_b16 v[52:53], v17 offset:36864
    ds_read_b64_tr_b16 v[54:55], v17 offset:38400
    v_mfma_f32_32x32x16_bf16 v[80:95], v[32:35], v[224:227], v[80:95]
    ds_read_b64_tr_b16 v[56:57], v17 offset:39936
    ds_read_b64_tr_b16 v[58:59], v17 offset:41472
    v_mfma_f32_32x32x16_bf16 v[96:111], v[36:39], v[224:227], v[96:111]
    ds_read_b64_tr_b16 v[60:61], v17 offset:43008
    ds_read_b64_tr_b16 v[62:63], v17 offset:44544
    s_waitcnt vmcnt(6) lgkmcnt(10)
    v_mfma_f32_32x32x16_bf16 v[64:79], v[40:43], v[228:231], v[64:79]
    ds_read_b64_tr_b16 v[28:29], v17 offset:46080
    ds_read_b64_tr_b16 v[30:31], v17 offset:47616
    s_waitcnt vmcnt(5) lgkmcnt(10)
    v_mfma_f32_32x32x16_bf16 v[64:79], v[44:47], v[232:235], v[64:79]
    ds_read_b128 v[32:35], v4 offset:61440
    s_waitcnt vmcnt(4) lgkmcnt(9)
    v_mfma_f32_32x32x16_bf16 v[64:79], v[48:51], v[236:239], v[64:79]
    ds_read_b64_tr_b16 v[36:37], v17 offset:27712
    ds_read_b64_tr_b16 v[38:39], v17 offset:29248
    s_waitcnt vmcnt(3) lgkmcnt(9)
    v_mfma_f32_32x32x16_bf16 v[64:79], v[52:55], v[240:243], v[64:79]
    ds_read_b64_tr_b16 v[40:41], v17 offset:30784
    ds_read_b64_tr_b16 v[42:43], v17 offset:32320
    s_waitcnt vmcnt(2) lgkmcnt(9)
    v_mfma_f32_32x32x16_bf16 v[64:79], v[56:59], v[244:247], v[64:79]
    ds_read_b64_tr_b16 v[44:45], v17 offset:33856
    ds_read_b64_tr_b16 v[46:47], v17 offset:35392
    s_waitcnt vmcnt(1) lgkmcnt(9)
    v_mfma_f32_32x32x16_bf16 v[64:79], v[60:63], v[248:251], v[64:79]
    ds_read_b64_tr_b16 v[48:49], v17 offset:36928
    ds_read_b64_tr_b16 v[50:51], v17 offset:38464
    s_waitcnt vmcnt(0) lgkmcnt(9)
    v_mfma_f32_32x32x16_bf16 v[64:79], v[28:31], v[252:255], v[64:79]
    ds_read_b64_tr_b16 v[52:53], v17 offset:40000
    ds_read_b64_tr_b16 v[54:55], v17 offset:41536
    s_waitcnt lgkmcnt(10)
    v_mfma_f32_32x32x16_bf16 v[64:79], v[32:35], v[24:27], v[64:79]
    ds_read_b64_tr_b16 v[56:57], v17 offset:43072
    ds_read_b64_tr_b16 v[58:59], v17 offset:44608
    s_waitcnt lgkmcnt(10)
    v_mfma_f32_32x32x16_bf16 v[80:95], v[36:39], v[228:231], v[80:95]
    ds_read_b64_tr_b16 v[60:61], v17 offset:46144
    ds_read_b64_tr_b16 v[62:63], v17 offset:47680
    s_waitcnt lgkmcnt(10)
    v_mfma_f32_32x32x16_bf16 v[80:95], v[40:43], v[232:235], v[80:95]
    ds_read_b128 v[28:31], v4 offset:62464
    s_waitcnt lgkmcnt(9)
    v_mfma_f32_32x32x16_bf16 v[80:95], v[44:47], v[236:239], v[80:95]
    ds_read_b64_tr_b16 v[32:33], v17 offset:27776
    ds_read_b64_tr_b16 v[34:35], v17 offset:29312
    s_mul_i32 s30, s93, 3
    s_add_u32 s30, s30, 0
    s_lshr_b32 s31, s30, 4
    s_cmp_eq_u32 s31, 0
    s_cselect_b32 s32, 0x3eb8aa3b, 1.0
    v_mul_f32 v2, s32, v21
    s_lshl_b32 s33, s30, 17
    s_add_u32 s33, s33, s38
    s_lshl_b32 s34, s92, 10
    s_add_u32 s33, s33, s34
    s_add_u32 s34, s33, 65536
    s_waitcnt lgkmcnt(9)
    v_mfma_f32_32x32x16_bf16 v[80:95], v[48:51], v[240:243], v[80:95]
    ds_read_b64_tr_b16 v[36:37], v17 offset:30848
    ds_read_b64_tr_b16 v[38:39], v17 offset:32384
    v_mul_f32 v64, v2, v64
    v_mul_f32 v65, v2, v65
    v_mul_f32 v66, v2, v66
    v_mul_f32 v67, v2, v67
    v_mul_f32 v68, v2, v68
    s_waitcnt lgkmcnt(9)
    v_mfma_f32_32x32x16_bf16 v[80:95], v[52:55], v[244:247], v[80:95]
    ds_read_b64_tr_b16 v[40:41], v17 offset:33920
    ds_read_b64_tr_b16 v[42:43], v17 offset:35456
    v_mul_f32 v69, v2, v69
    v_mul_f32 v70, v2, v70
    v_mul_f32 v71, v2, v71
    v_mul_f32 v72, v2, v72
    v_mul_f32 v73, v2, v73
    s_waitcnt lgkmcnt(9)
    v_mfma_f32_32x32x16_bf16 v[80:95], v[56:59], v[248:251], v[80:95]
    ds_read_b64_tr_b16 v[44:45], v17 offset:36992
    ds_read_b64_tr_b16 v[46:47], v17 offset:38528
    v_mul_f32 v74, v2, v74
    v_mul_f32 v75, v2, v75
    v_mul_f32 v76, v2, v76
    v_mul_f32 v77, v2, v77
    v_mul_f32 v78, v2, v78
    s_waitcnt lgkmcnt(9)
    v_mfma_f32_32x32x16_bf16 v[80:95], v[60:63], v[252:255], v[80:95]
    ds_read_b64_tr_b16 v[48:49], v17 offset:40064
    ds_read_b64_tr_b16 v[50:51], v17 offset:41600
    v_mul_f32 v79, v2, v79
    v_cvt_pk_bf16_f32 v112, v64, v65
    v_cvt_pk_bf16_f32 v113, v66, v67
    v_cvt_pk_bf16_f32 v114, v68, v69
    v_cvt_pk_bf16_f32 v115, v70, v71
    s_waitcnt lgkmcnt(10)
    v_mfma_f32_32x32x16_bf16 v[80:95], v[28:31], v[24:27], v[80:95]
    ds_read_b64_tr_b16 v[52:53], v17 offset:43136
    ds_read_b64_tr_b16 v[54:55], v17 offset:44672
    v_cvt_pk_bf16_f32 v116, v72, v73
    v_cvt_pk_bf16_f32 v117, v74, v75
    v_cvt_pk_bf16_f32 v118, v76, v77
    v_cvt_pk_bf16_f32 v119, v78, v79
    s_cmp_eq_u32 s31, 2
    s_cbranch_scc1 Lv_89
    buffer_store_dwordx4 v[112:115], v4, s[12:15], s33 offen sc1
    buffer_store_dwordx4 v[116:119], v4, s[12:15], s34 offen sc1
Le_90:
    s_waitcnt lgkmcnt(10)
    v_mfma_f32_32x32x16_bf16 v[96:111], v[32:35], v[228:231], v[96:111]
    ds_read_b64_tr_b16 v[56:57], v17 offset:46208
    ds_read_b64_tr_b16 v[58:59], v17 offset:47744
    s_waitcnt lgkmcnt(10)
    v_mfma_f32_32x32x16_bf16 v[96:111], v[36:39], v[232:235], v[96:111]
    ds_read_b128 v[60:63], v4 offset:63488
    s_waitcnt lgkmcnt(9)
    v_mfma_f32_32x32x16_bf16 v[96:111], v[40:43], v[236:239], v[96:111]
    s_mul_i32 s30, s93, 3
    s_add_u32 s30, s30, 1
    s_lshr_b32 s31, s30, 4
    s_cmp_eq_u32 s31, 0
    s_cselect_b32 s32, 0x3eb8aa3b, 1.0
    v_mul_f32 v2, s32, v21
    s_lshl_b32 s33, s30, 17
    s_add_u32 s33, s33, s38
    s_lshl_b32 s34, s92, 10
    s_add_u32 s33, s33, s34
    s_add_u32 s34, s33, 65536
    s_waitcnt lgkmcnt(7)
    v_mfma_f32_32x32x16_bf16 v[96:111], v[44:47], v[240:243], v[96:111]
    v_mul_f32 v80, v2, v80
    v_mul_f32 v81, v2, v81
    v_mul_f32 v82, v2, v82
    v_mul_f32 v83, v2, v83
    v_mul_f32 v84, v2, v84
    s_waitcnt lgkmcnt(5)
    v_mfma_f32_32x32x16_bf16 v[96:111], v[48:51], v[244:247], v[96:111]
    v_mul_f32 v85, v2, v85
    v_mul_f32 v86, v2, v86
    v_mul_f32 v87, v2, v87
    v_mul_f32 v88, v2, v88
    v_mul_f32 v89, v2, v89
    s_waitcnt lgkmcnt(3)
    v_mfma_f32_32x32x16_bf16 v[96:111], v[52:55], v[248:251], v[96:111]
    v_mul_f32 v90, v2, v90
    v_mul_f32 v91, v2, v91
    v_mul_f32 v92, v2, v92
    v_mul_f32 v93, v2, v93
    v_mul_f32 v94, v2, v94
    s_waitcnt lgkmcnt(1)
    v_mfma_f32_32x32x16_bf16 v[96:111], v[56:59], v[252:255], v[96:111]
    v_mul_f32 v95, v2, v95
    v_cvt_pk_bf16_f32 v120, v80, v81
    v_cvt_pk_bf16_f32 v121, v82, v83
    v_cvt_pk_bf16_f32 v122, v84, v85
    v_cvt_pk_bf16_f32 v123, v86, v87
    s_waitcnt lgkmcnt(0)
    v_mfma_f32_32x32x16_bf16 v[96:111], v[60:63], v[24:27], v[96:111]
    v_cvt_pk_bf16_f32 v124, v88, v89
    v_cvt_pk_bf16_f32 v125, v90, v91
    v_cvt_pk_bf16_f32 v126, v92, v93
    v_cvt_pk_bf16_f32 v127, v94, v95
    s_cmp_eq_u32 s31, 2
    s_cbranch_scc1 Lv_91
    buffer_store_dwordx4 v[120:123], v4, s[12:15], s33 offen sc1
    buffer_store_dwordx4 v[124:127], v4, s[12:15], s34 offen sc1
Le_92:
    s_barrier
    s_mul_i32 s30, s93, 3
    s_add_u32 s30, s30, 2
    s_lshr_b32 s31, s30, 4
    s_cmp_eq_u32 s31, 0
    s_cselect_b32 s32, 0x3eb8aa3b, 1.0
    v_mul_f32 v2, s32, v21
    s_lshl_b32 s33, s30, 17
    s_add_u32 s33, s33, s38
    s_lshl_b32 s34, s92, 10
    s_add_u32 s33, s33, s34
    s_add_u32 s34, s33, 65536
    v_mul_f32 v96, v2, v96
    v_mul_f32 v97, v2, v97
    v_mul_f32 v98, v2, v98
    v_mul_f32 v99, v2, v99
    v_mul_f32 v100, v2, v100
    v_mul_f32 v101, v2, v101
    v_mul_f32 v102, v2, v102
    v_mul_f32 v103, v2, v103
    v_mul_f32 v104, v2, v104
    v_mul_f32 v105, v2, v105
    v_mul_f32 v106, v2, v106
    v_mul_f32 v107, v2, v107
    v_mul_f32 v108, v2, v108
    v_mul_f32 v109, v2, v109
    v_mul_f32 v110, v2, v110
    v_mul_f32 v111, v2, v111
    v_cvt_pk_bf16_f32 v112, v96, v97
    v_cvt_pk_bf16_f32 v113, v98, v99
    v_cvt_pk_bf16_f32 v114, v100, v101
    v_cvt_pk_bf16_f32 v115, v102, v103
    v_cvt_pk_bf16_f32 v116, v104, v105
    v_cvt_pk_bf16_f32 v117, v106, v107
    v_cvt_pk_bf16_f32 v118, v108, v109
    v_cvt_pk_bf16_f32 v119, v110, v111
    s_cmp_eq_u32 s31, 2
    s_cbranch_scc1 Lv_93
    buffer_store_dwordx4 v[112:115], v4, s[12:15], s33 offen sc1
    buffer_store_dwordx4 v[116:119], v4, s[12:15], s34 offen sc1
Le_94:
    s_nop 1
    s_waitcnt vmcnt(0)
    v_mov_b32 v2, 1
    v_mov_b32 v3, 162816
    s_mov_b64 exec, 1
    ds_add_rtn_u32 v3, v3, v2 offset:60
    s_mov_b64 exec, -1
    s_waitcnt lgkmcnt(0)
    v_readfirstlane_b32 s28, v3
    s_nop 0
    s_add_u32 s28, s28, 1
    s_cmp_eq_u32 s28, s100
    s_cselect_b32 s39, s39, s98
    v_mov_b32 v2, s8
    v_mov_b32 v3, s9
    v_mov_b32 v7, 0
    s_mov_b64 exec, 1
    buffer_store_dwordx2 v[2:3], v7, s[12:15], s39 offen sc1
    s_mov_b64 exec, -1
    s_setprio 0
    s_nop 0
mega_next:
    s_add_u32 s22, s22, 0x2000000
    s_add_u32 s100, s100, 4
    s_branch mega_layer
mega_out:
    v_and_b32 v2, 31, v1
    v_lshlrev_b32 v2, 10, v2
    v_lshl_add_u32 v2, v5, 4, v2
    s_lshl_b32 s30, s40, 15
    s_lshl_b32 s31, s43, 6
    s_add_u32 s30, s30, s31
    s_nop 7
    s_waitcnt lgkmcnt(3)
    v_add_f32 v20, v20, v36
    v_add_f32 v21, v21, v37
    v_add_f32 v22, v22, v38
    v_add_f32 v23, v23, v39
    v_cvt_pk_bf16_f32 v8, v20, v21
    v_cvt_pk_bf16_f32 v9, v22, v23
    s_waitcnt lgkmcnt(2)
    v_add_f32 v24, v24, v40
    v_add_f32 v25, v25, v41
    v_add_f32 v26, v26, v42
    v_add_f32 v27, v27, v43
    v_cvt_pk_bf16_f32 v10, v24, v25
    v_cvt_pk_bf16_f32 v11, v26, v27
    s_waitcnt lgkmcnt(1)
    v_add_f32 v28, v28, v44
    v_add_f32 v29, v29, v45
    v_add_f32 v30, v30, v46
    v_add_f32 v31, v31, v47
    v_cvt_pk_bf16_f32 v12, v28, v29
    v_cvt_pk_bf16_f32 v13, v30, v31
    s_waitcnt lgkmcnt(0)
    v_add_f32 v32, v32, v48
    v_add_f32 v33, v33, v49
    v_add_f32 v34, v34, v50
    v_add_f32 v35, v35, v51
    v_cvt_pk_bf16_f32 v14, v32, v33
    v_cvt_pk_bf16_f32 v15, v34, v35
    v_permlane32_swap_b32 v8, v10
    v_permlane32_swap_b32 v9, v11
    buffer_store_dwordx4 v[8:11], v2, s[16:19], s30 offen
    v_permlane32_swap_b32 v12, v14
    v_permlane32_swap_b32 v13, v15
    buffer_store_dwordx4 v[12:15], v2, s[16:19], s30 offen offset:32
    s_nop 3
mega_fin:
mega_end:
    s_endpgm
Lslow_13:
    s_waitcnt vmcnt(0)
    v_mov_b32 v16, v4
    v_mov_b32 v2, 0xff800000
    s_mov_b32 s25, 0
    s_nop 3
Lmloop_95:
    ds_read_b128 v[20:23], v16
    ds_read_b128 v[24:27], v16 offset:1024
    v_add_u32 v16, 2048, v16
    s_waitcnt lgkmcnt(0)
    v_mfma_f32_32x32x16_bf16 v[44:59], v[20:23], v[84:87], 0
    v_mfma_f32_32x32x16_bf16 v[60:75], v[24:27], v[84:87], 0
    s_nop 10
    v_max3_f32 v2, v44, v45, v2
    v_max3_f32 v2, v46, v47, v2
    v_max3_f32 v2, v48, v49, v2
    v_max3_f32 v2, v50, v51, v2
    v_max3_f32 v2, v52, v53, v2
    v_max3_f32 v2, v54, v55, v2
    v_max3_f32 v2, v56, v57, v2
    v_max3_f32 v2, v58, v59, v2
    v_max3_f32 v2, v60, v61, v2
    v_max3_f32 v2, v62, v63, v2
    v_max3_f32 v2, v64, v65, v2
    v_max3_f32 v2, v66, v67, v2
    v_max3_f32 v2, v68, v69, v2
    v_max3_f32 v2, v70, v71, v2
    v_max3_f32 v2, v72, v73, v2
    v_max3_f32 v2, v74, v75, v2
    s_add_u32 s25, s25, 1
    s_cmp_lt_u32 s25, 32
    s_nop 2
    s_cbranch_scc1 Lmloop_95
    v_mov_b32 v3, v2
    s_nop 1
    v_permlane32_swap_b32 v2, v3
    v_max_f32 v2, v2, v3
    v_sub_f32 v124, 0, v2
    v_sub_f32 v125, 0, v2
    v_sub_f32 v126, 0, v2
    v_sub_f32 v127, 0, v2
    v_sub_f32 v128, 0, v2
    v_sub_f32 v129, 0, v2
    v_sub_f32 v130, 0, v2
    v_sub_f32 v131, 0, v2
    v_sub_f32 v132, 0, v2
    v_sub_f32 v133, 0, v2
    v_sub_f32 v134, 0, v2
    v_sub_f32 v135, 0, v2
    v_sub_f32 v136, 0, v2
    v_sub_f32 v137, 0, v2
    v_sub_f32 v138, 0, v2
    v_sub_f32 v139, 0, v2
    v_mov_b32 v16, v4
    v_mov_b32 v2, 0xff800000
    s_mov_b32 s25, 0
    s_nop 3
Lmloop_96:
    ds_read_b128 v[20:23], v16
    ds_read_b128 v[24:27], v16 offset:1024
    v_add_u32 v16, 2048, v16
    s_waitcnt lgkmcnt(0)
    v_mfma_f32_32x32x16_bf16 v[44:59], v[20:23], v[88:91], 0
    v_mfma_f32_32x32x16_bf16 v[60:75], v[24:27], v[88:91], 0
    s_nop 10
    v_max3_f32 v2, v44, v45, v2
    v_max3_f32 v2, v46, v47, v2
    v_max3_f32 v2, v48, v49, v2
    v_max3_f32 v2, v50, v51, v2
    v_max3_f32 v2, v52, v53, v2
    v_max3_f32 v2, v54, v55, v2
    v_max3_f32 v2, v56, v57, v2
    v_max3_f32 v2, v58, v59, v2
    v_max3_f32 v2, v60, v61, v2
    v_max3_f32 v2, v62, v63, v2
    v_max3_f32 v2, v64, v65, v2
    v_max3_f32 v2, v66, v67, v2
    v_max3_f32 v2, v68, v69, v2
    v_max3_f32 v2, v70, v71, v2
    v_max3_f32 v2, v72, v73, v2
    v_max3_f32 v2, v74, v75, v2
    s_add_u32 s25, s25, 1
    s_cmp_lt_u32 s25, 32
    s_nop 2
    s_cbranch_scc1 Lmloop_96
    v_mov_b32 v3, v2
    s_nop 1
    v_permlane32_swap_b32 v2, v3
    v_max_f32 v2, v2, v3
    v_sub_f32 v140, 0, v2
    v_sub_f32 v141, 0, v2
    v_sub_f32 v142, 0, v2
    v_sub_f32 v143, 0, v2
    v_sub_f32 v144, 0, v2
    v_sub_f32 v145, 0, v2
    v_sub_f32 v146, 0, v2
    v_sub_f32 v147, 0, v2
    v_sub_f32 v148, 0, v2
    v_sub_f32 v149, 0, v2
    v_sub_f32 v150, 0, v2
    v_sub_f32 v151, 0, v2
    v_sub_f32 v152, 0, v2
    v_sub_f32 v153, 0, v2
    v_sub_f32 v154, 0, v2
    v_sub_f32 v155, 0, v2
    s_mov_b32 s26, 1
    v_mov_b32 v92, 0
    v_mov_b32 v93, 0
    v_mov_b32 v94, 0
    v_mov_b32 v95, 0
    v_mov_b32 v96, 0
    v_mov_b32 v97, 0
    v_mov_b32 v98, 0
    v_mov_b32 v99, 0
    v_mov_b32 v100, 0
    v_mov_b32 v101, 0
    v_mov_b32 v102, 0
    v_mov_b32 v103, 0
    v_mov_b32 v104, 0
    v_mov_b32 v105, 0
    v_mov_b32 v106, 0
    v_mov_b32 v107, 0
    v_mov_b32 v108, 0
    v_mov_b32 v109, 0
    v_mov_b32 v110, 0
    v_mov_b32 v111, 0
    v_mov_b32 v112, 0
    v_mov_b32 v113, 0
    v_mov_b32 v114, 0
    v_mov_b32 v115, 0
    v_mov_b32 v116, 0
    v_mov_b32 v117, 0
    v_mov_b32 v118, 0
    v_mov_b32 v119, 0
    v_mov_b32 v120, 0
    v_mov_b32 v121, 0
    v_mov_b32 v122, 0
    v_mov_b32 v123, 0
    v_mov_b32 v80, 0
    v_mov_b32 v40, 0
    v_mov_b32 v81, 0
    v_mov_b32 v41, 0
    v_mov_b32 v82, 0
    v_mov_b32 v42, 0
    v_mov_b32 v83, 0
    v_mov_b32 v43, 0
    v_mov_b32 v16, v4
    v_and_b32 v3, 15, v1
    v_lshlrev_b32 v3, 4, v3
    v_lshl_add_u32 v3, v5, 8, v3
    v_and_b32 v2, 16, v1
    v_cmp_eq_u32 vcc, 0, v2
    v_mov_b32 v2, 131072
    v_mov_b32 v17, 65536
    v_mov_b32 v18, 8192
    v_cndmask_b32 v17, v2, v17, vcc
    v_cndmask_b32 v18, 0, v18, vcc
    v_add_u32 v17, v17, v3
    s_mov_b32 s25, 0
    ds_read_b128 v[20:23], v16
    ds_read_b128 v[24:27], v16 offset:1024
    ds_read_b128 v[28:31], v17
    ds_read_b128 v[32:35], v17 offset:512
    s_waitcnt lgkmcnt(0)
    v_mfma_f32_32x32x16_bf16 v[44:59], v[20:23], v[84:87], v[124:139]
    s_nop 11
Lloop_97:
    v_mfma_f32_32x32x16_bf16 v[60:75], v[20:23], v[88:91], v[140:155]
    v_exp_f32 v44, v44
    v_exp_f32 v45, v45
    v_exp_f32 v46, v46
    v_exp_f32 v47, v47
    v_mfma_f32_32x32x16_bf16 v[108:123], v[40:43], v[80:83], v[108:123]
    ds_read_b128 v[36:39], v17 offset:1024
    ds_read_b128 v[40:43], v17 offset:1536
    v_exp_f32 v48, v48
    v_cvt_pk_bf16_f32 v76, v44, v45
    v_exp_f32 v49, v49
    v_exp_f32 v50, v50
    v_cvt_pk_bf16_f32 v77, v46, v47
    v_exp_f32 v51, v51
    v_exp_f32 v52, v52
    v_cvt_pk_bf16_f32 v78, v48, v49
    v_exp_f32 v53, v53
    v_exp_f32 v54, v54
    v_cvt_pk_bf16_f32 v79, v50, v51
    v_exp_f32 v55, v55
    v_exp_f32 v56, v56
    v_mfma_f32_32x32x16_bf16 v[92:107], v[28:31], v[76:79], v[92:107]
    v_cvt_pk_bf16_f32 v80, v52, v53
    v_exp_f32 v57, v57
    v_exp_f32 v58, v58
    v_exp_f32 v59, v59
    v_cvt_pk_bf16_f32 v81, v54, v55
    v_cvt_pk_bf16_f32 v82, v56, v57
    v_cvt_pk_bf16_f32 v83, v58, v59
    s_waitcnt lgkmcnt(0)
    v_mfma_f32_32x32x16_bf16 v[44:59], v[24:27], v[84:87], v[124:139]
    ds_read_b128 v[20:23], v16 offset:2048
    v_exp_f32 v60, v60
    v_exp_f32 v61, v61
    v_exp_f32 v62, v62
    v_exp_f32 v63, v63
    v_mfma_f32_32x32x16_bf16 v[92:107], v[32:35], v[80:83], v[92:107]
    v_exp_f32 v64, v64
    v_cvt_pk_bf16_f32 v76, v60, v61
    v_exp_f32 v65, v65
    v_exp_f32 v66, v66
    v_cvt_pk_bf16_f32 v77, v62, v63
    v_exp_f32 v67, v67
    v_exp_f32 v68, v68
    v_cvt_pk_bf16_f32 v78, v64, v65
    v_exp_f32 v69, v69
    v_exp_f32 v70, v70
    v_cvt_pk_bf16_f32 v79, v66, v67
    v_exp_f32 v71, v71
    v_exp_f32 v72, v72
    v_mfma_f32_32x32x16_bf16 v[108:123], v[28:31], v[76:79], v[108:123]
    v_cvt_pk_bf16_f32 v80, v68, v69
    v_exp_f32 v73, v73
    v_exp_f32 v74, v74
    v_exp_f32 v75, v75
    v_cvt_pk_bf16_f32 v81, v70, v71
    v_cvt_pk_bf16_f32 v82, v72, v73
    v_cvt_pk_bf16_f32 v83, v74, v75
    v_mfma_f32_32x32x16_bf16 v[60:75], v[24:27], v[88:91], v[140:155]
    v_exp_f32 v44, v44
    v_exp_f32 v45, v45
    v_exp_f32 v46, v46
    v_exp_f32 v47, v47
    v_mfma_f32_32x32x16_bf16 v[108:123], v[32:35], v[80:83], v[108:123]
    ds_read_b128 v[28:31], v17 offset:2048
    ds_read_b128 v[32:35], v17 offset:2560
    v_exp_f32 v48, v48
    v_cvt_pk_bf16_f32 v76, v44, v45
    v_exp_f32 v49, v49
    v_exp_f32 v50, v50
    v_cvt_pk_bf16_f32 v77, v46, v47
    v_exp_f32 v51, v51
    v_exp_f32 v52, v52
    v_cvt_pk_bf16_f32 v78, v48, v49
    v_exp_f32 v53, v53
    v_exp_f32 v54, v54
    v_cvt_pk_bf16_f32 v79, v50, v51
    v_exp_f32 v55, v55
    v_exp_f32 v56, v56
    v_mfma_f32_32x32x16_bf16 v[92:107], v[36:39], v[76:79], v[92:107]
    v_cvt_pk_bf16_f32 v80, v52, v53
    v_exp_f32 v57, v57
    v_exp_f32 v58, v58
    v_exp_f32 v59, v59
    v_cvt_pk_bf16_f32 v81, v54, v55
    v_cvt_pk_bf16_f32 v82, v56, v57
    v_cvt_pk_bf16_f32 v83, v58, v59
    s_waitcnt lgkmcnt(0)
    v_mfma_f32_32x32x16_bf16 v[44:59], v[20:23], v[84:87], v[124:139]
    ds_read_b128 v[24:27], v16 offset:3072
    v_exp_f32 v60, v60
    v_exp_f32 v61, v61
    v_exp_f32 v62, v62
    v_exp_f32 v63, v63
    v_mfma_f32_32x32x16_bf16 v[92:107], v[40:43], v[80:83], v[92:107]
    v_exp_f32 v64, v64
    v_cvt_pk_bf16_f32 v76, v60, v61
    v_exp_f32 v65, v65
    v_exp_f32 v66, v66
    v_cvt_pk_bf16_f32 v77, v62, v63
    v_exp_f32 v67, v67
    v_exp_f32 v68, v68
    v_cvt_pk_bf16_f32 v78, v64, v65
    v_exp_f32 v69, v69
    v_exp_f32 v70, v70
    v_cvt_pk_bf16_f32 v79, v66, v67
    v_exp_f32 v71, v71
    v_exp_f32 v72, v72
    v_mfma_f32_32x32x16_bf16 v[108:123], v[36:39], v[76:79], v[108:123]
    v_cvt_pk_bf16_f32 v80, v68, v69
    v_exp_f32 v73, v73
    v_exp_f32 v74, v74
    v_exp_f32 v75, v75
    v_cvt_pk_bf16_f32 v81, v70, v71
    v_cvt_pk_bf16_f32 v82, v72, v73
    v_cvt_pk_bf16_f32 v83, v74, v75
    v_mfma_f32_32x32x16_bf16 v[60:75], v[20:23], v[88:91], v[140:155]
    v_exp_f32 v44, v44
    v_exp_f32 v45, v45
    v_exp_f32 v46, v46
    v_exp_f32 v47, v47
    v_mfma_f32_32x32x16_bf16 v[108:123], v[40:43], v[80:83], v[108:123]
    ds_read_b128 v[36:39], v17 offset:3072
    ds_read_b128 v[40:43], v17 offset:3584
    v_exp_f32 v48, v48
    v_cvt_pk_bf16_f32 v76, v44, v45
    v_exp_f32 v49, v49
    v_exp_f32 v50, v50
    v_cvt_pk_bf16_f32 v77, v46, v47
    v_exp_f32 v51, v51
    v_exp_f32 v52, v52
    v_cvt_pk_bf16_f32 v78, v48, v49
    v_exp_f32 v53, v53
    v_exp_f32 v54, v54
    v_cvt_pk_bf16_f32 v79, v50, v51
    v_exp_f32 v55, v55
    v_exp_f32 v56, v56
    v_mfma_f32_32x32x16_bf16 v[92:107], v[28:31], v[76:79], v[92:107]
    v_cvt_pk_bf16_f32 v80, v52, v53
    v_exp_f32 v57, v57
    v_exp_f32 v58, v58
    v_exp_f32 v59, v59
    v_cvt_pk_bf16_f32 v81, v54, v55
    v_cvt_pk_bf16_f32 v82, v56, v57
    v_cvt_pk_bf16_f32 v83, v58, v59
    s_waitcnt lgkmcnt(0)
    v_mfma_f32_32x32x16_bf16 v[44:59], v[24:27], v[84:87], v[124:139]
    ds_read_b128 v[20:23], v16 offset:4096
    v_exp_f32 v60, v60
    v_exp_f32 v61, v61
    v_exp_f32 v62, v62
    v_exp_f32 v63, v63
    v_mfma_f32_32x32x16_bf16 v[92:107], v[32:35], v[80:83], v[92:107]
    v_exp_f32 v64, v64
    v_cvt_pk_bf16_f32 v76, v60, v61
    v_exp_f32 v65, v65
    v_exp_f32 v66, v66
    v_cvt_pk_bf16_f32 v77, v62, v63
    v_exp_f32 v67, v67
    v_exp_f32 v68, v68
    v_cvt_pk_bf16_f32 v78, v64, v65
    v_exp_f32 v69, v69
    v_exp_f32 v70, v70
    v_cvt_pk_bf16_f32 v79, v66, v67
    v_exp_f32 v71, v71
    v_exp_f32 v72, v72
    v_mfma_f32_32x32x16_bf16 v[108:123], v[28:31], v[76:79], v[108:123]
    v_cvt_pk_bf16_f32 v80, v68, v69
    v_exp_f32 v73, v73
    v_exp_f32 v74, v74
    v_exp_f32 v75, v75
    v_cvt_pk_bf16_f32 v81, v70, v71
    v_cvt_pk_bf16_f32 v82, v72, v73
    v_cvt_pk_bf16_f32 v83, v74, v75
    v_mfma_f32_32x32x16_bf16 v[60:75], v[24:27], v[88:91], v[140:155]
    v_exp_f32 v44, v44
    v_exp_f32 v45, v45
    v_exp_f32 v46, v46
    v_exp_f32 v47, v47
    v_mfma_f32_32x32x16_bf16 v[108:123], v[32:35], v[80:83], v[108:123]
    ds_read_b128 v[28:31], v17 offset:4096
    ds_read_b128 v[32:35], v17 offset:4608
    v_exp_f32 v48, v48
    v_cvt_pk_bf16_f32 v76, v44, v45
    v_exp_f32 v49, v49
    v_exp_f32 v50, v50
    v_cvt_pk_bf16_f32 v77, v46, v47
    v_exp_f32 v51, v51
    v_exp_f32 v52, v52
    v_cvt_pk_bf16_f32 v78, v48, v49
    v_exp_f32 v53, v53
    v_exp_f32 v54, v54
    v_cvt_pk_bf16_f32 v79, v50, v51
    v_exp_f32 v55, v55
    v_exp_f32 v56, v56
    v_mfma_f32_32x32x16_bf16 v[92:107], v[36:39], v[76:79], v[92:107]
    v_cvt_pk_bf16_f32 v80, v52, v53
    v_exp_f32 v57, v57
    v_exp_f32 v58, v58
    v_exp_f32 v59, v59
    v_cvt_pk_bf16_f32 v81, v54, v55
    v_cvt_pk_bf16_f32 v82, v56, v57
    v_cvt_pk_bf16_f32 v83, v58, v59
    s_waitcnt lgkmcnt(0)
    v_mfma_f32_32x32x16_bf16 v[44:59], v[20:23], v[84:87], v[124:139]
    ds_read_b128 v[24:27], v16 offset:5120
    v_exp_f32 v60, v60
    v_exp_f32 v61, v61
    v_exp_f32 v62, v62
    v_exp_f32 v63, v63
    v_mfma_f32_32x32x16_bf16 v[92:107], v[40:43], v[80:83], v[92:107]
    v_exp_f32 v64, v64
    v_cvt_pk_bf16_f32 v76, v60, v61
    v_exp_f32 v65, v65
    v_exp_f32 v66, v66
    v_cvt_pk_bf16_f32 v77, v62, v63
    v_exp_f32 v67, v67
    v_exp_f32 v68, v68
    v_cvt_pk_bf16_f32 v78, v64, v65
    v_exp_f32 v69, v69
    v_exp_f32 v70, v70
    v_cvt_pk_bf16_f32 v79, v66, v67
    v_exp_f32 v71, v71
    v_exp_f32 v72, v72
    v_mfma_f32_32x32x16_bf16 v[108:123], v[36:39], v[76:79], v[108:123]
    v_cvt_pk_bf16_f32 v80, v68, v69
    v_exp_f32 v73, v73
    v_exp_f32 v74, v74
    v_exp_f32 v75, v75
    v_cvt_pk_bf16_f32 v81, v70, v71
    v_cvt_pk_bf16_f32 v82, v72, v73
    v_cvt_pk_bf16_f32 v83, v74, v75
    v_mfma_f32_32x32x16_bf16 v[60:75], v[20:23], v[88:91], v[140:155]
    v_exp_f32 v44, v44
    v_exp_f32 v45, v45
    v_exp_f32 v46, v46
    v_exp_f32 v47, v47
    v_mfma_f32_32x32x16_bf16 v[108:123], v[40:43], v[80:83], v[108:123]
    ds_read_b128 v[36:39], v17 offset:5120
    ds_read_b128 v[40:43], v17 offset:5632
    v_exp_f32 v48, v48
    v_cvt_pk_bf16_f32 v76, v44, v45
    v_exp_f32 v49, v49
    v_exp_f32 v50, v50
    v_cvt_pk_bf16_f32 v77, v46, v47
    v_exp_f32 v51, v51
    v_exp_f32 v52, v52
    v_cvt_pk_bf16_f32 v78, v48, v49
    v_exp_f32 v53, v53
    v_exp_f32 v54, v54
    v_cvt_pk_bf16_f32 v79, v50, v51
    v_exp_f32 v55, v55
    v_exp_f32 v56, v56
    v_mfma_f32_32x32x16_bf16 v[92:107], v[28:31], v[76:79], v[92:107]
    v_cvt_pk_bf16_f32 v80, v52, v53
    v_exp_f32 v57, v57
    v_exp_f32 v58, v58
    v_exp_f32 v59, v59
    v_cvt_pk_bf16_f32 v81, v54, v55
    v_cvt_pk_bf16_f32 v82, v56, v57
    v_cvt_pk_bf16_f32 v83, v58, v59
    s_waitcnt lgkmcnt(0)
    v_mfma_f32_32x32x16_bf16 v[44:59], v[24:27], v[84:87], v[124:139]
    ds_read_b128 v[20:23], v16 offset:6144
    v_exp_f32 v60, v60
    v_exp_f32 v61, v61
    v_exp_f32 v62, v62
    v_exp_f32 v63, v63
    v_mfma_f32_32x32x16_bf16 v[92:107], v[32:35], v[80:83], v[92:107]
    v_exp_f32 v64, v64
    v_cvt_pk_bf16_f32 v76, v60, v61
    v_exp_f32 v65, v65
    v_exp_f32 v66, v66
    v_cvt_pk_bf16_f32 v77, v62, v63
    v_exp_f32 v67, v67
    v_exp_f32 v68, v68
    v_cvt_pk_bf16_f32 v78, v64, v65
    v_exp_f32 v69, v69
    v_exp_f32 v70, v70
    v_cvt_pk_bf16_f32 v79, v66, v67
    v_exp_f32 v71, v71
    v_exp_f32 v72, v72
    v_mfma_f32_32x32x16_bf16 v[108:123], v[28:31], v[76:79], v[108:123]
    v_cvt_pk_bf16_f32 v80, v68, v69
    v_exp_f32 v73, v73
    v_exp_f32 v74, v74
    v_exp_f32 v75, v75
    v_cvt_pk_bf16_f32 v81, v70, v71
    v_cvt_pk_bf16_f32 v82, v72, v73
    v_cvt_pk_bf16_f32 v83, v74, v75
    v_mfma_f32_32x32x16_bf16 v[60:75], v[24:27], v[88:91], v[140:155]
    v_exp_f32 v44, v44
    v_exp_f32 v45, v45
    v_exp_f32 v46, v46
    v_exp_f32 v47, v47
    v_mfma_f32_32x32x16_bf16 v[108:123], v[32:35], v[80:83], v[108:123]
    ds_read_b128 v[28:31], v17 offset:6144
    ds_read_b128 v[32:35], v17 offset:6656
    v_exp_f32 v48, v48
    v_cvt_pk_bf16_f32 v76, v44, v45
    v_exp_f32 v49, v49
    v_exp_f32 v50, v50
    v_cvt_pk_bf16_f32 v77, v46, v47
    v_exp_f32 v51, v51
    v_exp_f32 v52, v52
    v_cvt_pk_bf16_f32 v78, v48, v49
    v_exp_f32 v53, v53
    v_exp_f32 v54, v54
    v_cvt_pk_bf16_f32 v79, v50, v51
    v_exp_f32 v55, v55
    v_exp_f32 v56, v56
    v_mfma_f32_32x32x16_bf16 v[92:107], v[36:39], v[76:79], v[92:107]
    v_cvt_pk_bf16_f32 v80, v52, v53
    v_exp_f32 v57, v57
    v_exp_f32 v58, v58
    v_exp_f32 v59, v59
    v_cvt_pk_bf16_f32 v81, v54, v55
    v_cvt_pk_bf16_f32 v82, v56, v57
    v_cvt_pk_bf16_f32 v83, v58, v59
    s_waitcnt lgkmcnt(0)
    v_mfma_f32_32x32x16_bf16 v[44:59], v[20:23], v[84:87], v[124:139]
    ds_read_b128 v[24:27], v16 offset:7168
    v_exp_f32 v60, v60
    v_exp_f32 v61, v61
    v_exp_f32 v62, v62
    v_exp_f32 v63, v63
    v_mfma_f32_32x32x16_bf16 v[92:107], v[40:43], v[80:83], v[92:107]
    v_exp_f32 v64, v64
    v_cvt_pk_bf16_f32 v76, v60, v61
    v_exp_f32 v65, v65
    v_exp_f32 v66, v66
    v_cvt_pk_bf16_f32 v77, v62, v63
    v_exp_f32 v67, v67
    v_exp_f32 v68, v68
    v_cvt_pk_bf16_f32 v78, v64, v65
    v_exp_f32 v69, v69
    v_exp_f32 v70, v70
    v_cvt_pk_bf16_f32 v79, v66, v67
    v_exp_f32 v71, v71
    v_exp_f32 v72, v72
    v_mfma_f32_32x32x16_bf16 v[108:123], v[36:39], v[76:79], v[108:123]
    v_cvt_pk_bf16_f32 v80, v68, v69
    v_exp_f32 v73, v73
    v_exp_f32 v74, v74
    v_exp_f32 v75, v75
    v_cvt_pk_bf16_f32 v81, v70, v71
    v_cvt_pk_bf16_f32 v82, v72, v73
    v_cvt_pk_bf16_f32 v83, v74, v75
    v_mfma_f32_32x32x16_bf16 v[60:75], v[20:23], v[88:91], v[140:155]
    v_exp_f32 v44, v44
    v_exp_f32 v45, v45
    v_exp_f32 v46, v46
    v_exp_f32 v47, v47
    v_mfma_f32_32x32x16_bf16 v[108:123], v[40:43], v[80:83], v[108:123]
    ds_read_b128 v[36:39], v17 offset:7168
    ds_read_b128 v[40:43], v17 offset:7680
    v_exp_f32 v48, v48
    v_cvt_pk_bf16_f32 v76, v44, v45
    v_exp_f32 v49, v49
    v_exp_f32 v50, v50
    v_cvt_pk_bf16_f32 v77, v46, v47
    v_exp_f32 v51, v51
    v_exp_f32 v52, v52
    v_cvt_pk_bf16_f32 v78, v48, v49
    v_exp_f32 v53, v53
    v_exp_f32 v54, v54
    v_cvt_pk_bf16_f32 v79, v50, v51
    v_exp_f32 v55, v55
    v_exp_f32 v56, v56
    v_mfma_f32_32x32x16_bf16 v[92:107], v[28:31], v[76:79], v[92:107]
    v_cvt_pk_bf16_f32 v80, v52, v53
    v_exp_f32 v57, v57
    v_exp_f32 v58, v58
    v_exp_f32 v59, v59
    v_cvt_pk_bf16_f32 v81, v54, v55
    v_cvt_pk_bf16_f32 v82, v56, v57
    v_cvt_pk_bf16_f32 v83, v58, v59
    s_waitcnt lgkmcnt(0)
    v_mfma_f32_32x32x16_bf16 v[44:59], v[24:27], v[84:87], v[124:139]
    ds_read_b128 v[20:23], v16 offset:8192
    v_exp_f32 v60, v60
    v_exp_f32 v61, v61
    v_exp_f32 v62, v62
    v_exp_f32 v63, v63
    v_mfma_f32_32x32x16_bf16 v[92:107], v[32:35], v[80:83], v[92:107]
    v_exp_f32 v64, v64
    v_cvt_pk_bf16_f32 v76, v60, v61
    v_exp_f32 v65, v65
    v_exp_f32 v66, v66
    v_cvt_pk_bf16_f32 v77, v62, v63
    v_exp_f32 v67, v67
    v_exp_f32 v68, v68
    v_cvt_pk_bf16_f32 v78, v64, v65
    v_exp_f32 v69, v69
    v_exp_f32 v70, v70
    v_cvt_pk_bf16_f32 v79, v66, v67
    v_exp_f32 v71, v71
    v_exp_f32 v72, v72
    v_mfma_f32_32x32x16_bf16 v[108:123], v[28:31], v[76:79], v[108:123]
    v_cvt_pk_bf16_f32 v80, v68, v69
    v_exp_f32 v73, v73
    v_exp_f32 v74, v74
    v_exp_f32 v75, v75
    v_cvt_pk_bf16_f32 v81, v70, v71
    v_cvt_pk_bf16_f32 v82, v72, v73
    v_cvt_pk_bf16_f32 v83, v74, v75
    v_mfma_f32_32x32x16_bf16 v[60:75], v[24:27], v[88:91], v[140:155]
    v_exp_f32 v44, v44
    v_exp_f32 v45, v45
    v_exp_f32 v46, v46
    v_exp_f32 v47, v47
    v_mfma_f32_32x32x16_bf16 v[108:123], v[32:35], v[80:83], v[108:123]
    ds_read_b128 v[28:31], v17 offset:8192
    ds_read_b128 v[32:35], v17 offset:8704
    v_exp_f32 v48, v48
    v_cvt_pk_bf16_f32 v76, v44, v45
    v_exp_f32 v49, v49
    v_exp_f32 v50, v50
    v_cvt_pk_bf16_f32 v77, v46, v47
    v_exp_f32 v51, v51
    v_exp_f32 v52, v52
    v_cvt_pk_bf16_f32 v78, v48, v49
    v_exp_f32 v53, v53
    v_exp_f32 v54, v54
    v_cvt_pk_bf16_f32 v79, v50, v51
    v_exp_f32 v55, v55
    v_exp_f32 v56, v56
    v_mfma_f32_32x32x16_bf16 v[92:107], v[36:39], v[76:79], v[92:107]
    v_cvt_pk_bf16_f32 v80, v52, v53
    v_exp_f32 v57, v57
    v_exp_f32 v58, v58
    v_exp_f32 v59, v59
    v_cvt_pk_bf16_f32 v81, v54, v55
    v_cvt_pk_bf16_f32 v82, v56, v57
    v_cvt_pk_bf16_f32 v83, v58, v59
    s_waitcnt lgkmcnt(0)
    v_mfma_f32_32x32x16_bf16 v[44:59], v[20:23], v[84:87], v[124:139]
    ds_read_b128 v[24:27], v16 offset:9216
    v_exp_f32 v60, v60
    v_exp_f32 v61, v61
    v_exp_f32 v62, v62
    v_exp_f32 v63, v63
    v_mfma_f32_32x32x16_bf16 v[92:107], v[40:43], v[80:83], v[92:107]
    v_exp_f32 v64, v64
    v_cvt_pk_bf16_f32 v76, v60, v61
    v_exp_f32 v65, v65
    v_exp_f32 v66, v66
    v_cvt_pk_bf16_f32 v77, v62, v63
    v_exp_f32 v67, v67
    v_exp_f32 v68, v68
    v_cvt_pk_bf16_f32 v78, v64, v65
    v_exp_f32 v69, v69
    v_exp_f32 v70, v70
    v_cvt_pk_bf16_f32 v79, v66, v67
    v_exp_f32 v71, v71
    v_exp_f32 v72, v72
    v_mfma_f32_32x32x16_bf16 v[108:123], v[36:39], v[76:79], v[108:123]
    v_cvt_pk_bf16_f32 v80, v68, v69
    v_exp_f32 v73, v73
    v_exp_f32 v74, v74
    v_exp_f32 v75, v75
    v_cvt_pk_bf16_f32 v81, v70, v71
    v_add_u32 v16, 8192, v16
    v_add_u32 v17, v18, v17
    s_add_u32 s25, s25, 1
    s_cmp_lt_u32 s25, 8
    v_cvt_pk_bf16_f32 v82, v72, v73
    v_cvt_pk_bf16_f32 v83, v74, v75
    s_cbranch_scc1 Lloop_97
    s_nop 0
    v_mfma_f32_32x32x16_bf16 v[108:123], v[40:43], v[80:83], v[108:123]
    s_nop 11
    s_branch Ltail_12
Lv_5:
    ds_write_b64 v18, v[112:113] offset:0
    ds_write_b64 v18, v[114:115] offset:16
    ds_write_b64 v18, v[116:117] offset:32
    ds_write_b64 v18, v[118:119] offset:48
    ds_read_b64_tr_b16 v[112:113], v19 offset:0
    ds_read_b64_tr_b16 v[114:115], v19 offset:576
    ds_read_b64_tr_b16 v[116:117], v19 offset:1152
    ds_read_b64_tr_b16 v[118:119], v19 offset:1728
    s_waitcnt lgkmcnt(0)
    buffer_store_dwordx4 v[112:115], v20, s[12:15], s33 offen sc1
    buffer_store_dwordx4 v[116:119], v20, s[12:15], s33 offen offset:512 sc1
    s_branch Le_6

Lv_7:
    ds_write_b64 v18, v[120:121] offset:0
    ds_write_b64 v18, v[122:123] offset:16
    ds_write_b64 v18, v[124:125] offset:32
    ds_write_b64 v18, v[126:127] offset:48
    ds_read_b64_tr_b16 v[120:121], v19 offset:0
    ds_read_b64_tr_b16 v[122:123], v19 offset:576
    ds_read_b64_tr_b16 v[124:125], v19 offset:1152
    ds_read_b64_tr_b16 v[126:127], v19 offset:1728
    s_waitcnt lgkmcnt(0)
    buffer_store_dwordx4 v[120:123], v20, s[12:15], s33 offen sc1
    buffer_store_dwordx4 v[124:127], v20, s[12:15], s33 offen offset:512 sc1
    s_branch Le_8

Lv_9:
    ds_write_b64 v18, v[112:113] offset:0
    ds_write_b64 v18, v[114:115] offset:16
    ds_write_b64 v18, v[116:117] offset:32
    ds_write_b64 v18, v[118:119] offset:48
    ds_read_b64_tr_b16 v[112:113], v19 offset:0
    ds_read_b64_tr_b16 v[114:115], v19 offset:576
    ds_read_b64_tr_b16 v[116:117], v19 offset:1152
    ds_read_b64_tr_b16 v[118:119], v19 offset:1728
    s_waitcnt lgkmcnt(0)
    buffer_store_dwordx4 v[112:115], v20, s[12:15], s33 offen sc1
    buffer_store_dwordx4 v[116:119], v20, s[12:15], s33 offen offset:512 sc1
    s_branch Le_10

Lpol_19:
    s_add_u32 s29, s29, 1
    s_mov_b32 s28, 0x10000
    s_mov_b32 exec_lo, 0xffffffff
    s_mov_b32 exec_hi, 0xffff
Lpoll_17:
    buffer_load_dwordx2 v[2:3], v19, s[12:15], s31 offen sc1
    s_sub_u32 s28, s28, 1
    s_cbranch_scc1 Lpolled_18
    s_waitcnt vmcnt(0)
    v_cmp_ne_u64 vcc, s[8:9], v[2:3]
    s_nop 4
    s_cbranch_vccnz Lpoll_17
Lpolled_18:
    s_waitcnt vmcnt(0)
    v_mov_b32 v7, s29
    v_mov_b32 v3, 162824
    ds_write_b32 v3, v7
    s_mov_b64 exec, -1
    s_waitcnt vmcnt(0)
    s_branch Lrel_20

Lnb_29_b:
    s_barrier
    s_branch Lnb_29

Lpol_33:
    s_add_u32 s29, s29, 1
    s_mov_b32 s28, 0x10000
    v_lshlrev_b32 v7, 3, v1
    s_mov_b32 exec_lo, 0xffffffff
    s_mov_b32 exec_hi, 0x0
    s_nop 2
Lpoll_31:
    buffer_load_dwordx2 v[2:3], v7, s[12:15], s42 offen sc1
    s_sub_u32 s28, s28, 1
    s_cbranch_scc1 Lpolled_32
    s_waitcnt vmcnt(0)
    v_cmp_ne_u64 vcc, s[8:9], v[2:3]
    s_nop 4
    s_cbranch_vccnz Lpoll_31
Lpolled_32:
    s_waitcnt vmcnt(0)
    v_mov_b32 v7, s29
    v_mov_b32 v3, 162824
    ds_write_b32 v3, v7
    s_mov_b64 exec, -1
    s_waitcnt vmcnt(0)
    s_branch Lrel_34

Lpol_40:
    s_add_u32 s29, s29, 1
    s_mov_b32 s28, 0x10000
    v_lshlrev_b32 v7, 3, v1
    s_mov_b32 exec_lo, 0xffffffff
    s_mov_b32 exec_hi, 0xffffffff
    s_nop 2
Lpoll_38:
    buffer_load_dwordx2 v[2:3], v7, s[12:15], s42 offen sc1
    s_sub_u32 s28, s28, 1
    s_cbranch_scc1 Lpolled_39
    s_waitcnt vmcnt(0)
    v_cmp_ne_u64 vcc, s[8:9], v[2:3]
    s_nop 4
    s_cbranch_vccnz Lpoll_38
Lpolled_39:
    s_waitcnt vmcnt(0)
    v_mov_b32 v7, s29
    v_mov_b32 v3, 162824
    ds_write_b32 v3, v7
    s_mov_b64 exec, -1
    s_waitcnt vmcnt(0)
    s_branch Lrel_41

Lpol_46:
    s_add_u32 s29, s29, 1
    s_mov_b32 s28, 0x10000
    v_lshlrev_b32 v7, 3, v1
    s_mov_b32 exec_lo, 0xffffffff
    s_mov_b32 exec_hi, 0xfffffff
    s_nop 2
Lpoll_44:
    buffer_load_dwordx2 v[2:3], v7, s[12:15], s43 offen sc1
    s_sub_u32 s28, s28, 1
    s_cbranch_scc1 Lpolled_45
    s_waitcnt vmcnt(0)
    v_cmp_ne_u64 vcc, s[8:9], v[2:3]
    s_nop 4
    s_cbranch_vccnz Lpoll_44
Lpolled_45:
    s_waitcnt vmcnt(0)
    v_mov_b32 v7, s29
    v_mov_b32 v3, 162824
    ds_write_b32 v3, v7
    s_mov_b64 exec, -1
    s_waitcnt vmcnt(0)
    s_branch Lrel_47

Lpol_51:
    s_add_u32 s29, s29, 1
    s_mov_b32 s28, 0x10000
    v_lshlrev_b32 v7, 3, v1
    s_mov_b32 exec_lo, 0xffffffff
    s_mov_b32 exec_hi, 0xffffffff
    s_nop 2
Lpoll_49:
    buffer_load_dwordx2 v[2:3], v7, s[12:15], s42 offen sc1
    s_sub_u32 s28, s28, 1
    s_cbranch_scc1 Lpolled_50
    s_waitcnt vmcnt(0)
    v_cmp_ne_u64 vcc, s[8:9], v[2:3]
    s_nop 4
    s_cbranch_vccnz Lpoll_49
Lpolled_50:
    s_waitcnt vmcnt(0)
    v_mov_b32 v7, s29
    v_mov_b32 v3, 162824
    ds_write_b32 v3, v7
    s_mov_b64 exec, -1
    s_waitcnt vmcnt(0)
    s_branch Lrel_52

Lss_56:
    buffer_store_dwordx4 v[8:11], v4, s[12:15], s30 offen sc1
    s_branch Lsd_57

Lss_58:
    buffer_store_dwordx4 v[12:15], v4, s[12:15], s30 offen offset:1024 sc1
    s_branch Lsd_59

Lss_60:
    buffer_store_dword v16, v4, s[12:15], s32 offen sc1
    s_branch Lsd_61

Lss_62:
    buffer_store_dwordx2 v[2:3], v7, s[12:15], s33 offen sc1
    s_branch Lsd_63

Lss_65:
    buffer_store_dwordx4 v[128:131], v4, s[12:15], s33 offen offset:0 sc1
    s_branch Lsd_66

Lss_67:
    buffer_store_dwordx4 v[132:135], v4, s[12:15], s33 offen offset:1024 sc1
    s_branch Lsd_68

Lss_69:
    buffer_store_dwordx4 v[136:139], v4, s[12:15], s34 offen offset:0 sc1
    s_branch Lsd_70

Lss_71:
    buffer_store_dwordx4 v[140:143], v4, s[12:15], s34 offen offset:1024 sc1
    s_branch Lsd_72

Lss_73:
    buffer_store_dwordx4 v[144:147], v4, s[12:15], s35 offen offset:0 sc1
    s_branch Lsd_74

Lss_75:
    buffer_store_dwordx4 v[148:151], v4, s[12:15], s35 offen offset:1024 sc1
    s_branch Lsd_76

Lss_77:
    buffer_store_dwordx2 v[2:3], v7, s[12:15], s32 offen sc1
    s_branch Lsd_78

Lss_80:
    buffer_store_dwordx4 v[8:11], v4, s[12:15], s30 offen sc1
    s_branch Lsd_81

Lss_82:
    buffer_store_dwordx4 v[12:15], v4, s[12:15], s30 offen offset:1024 sc1
    s_branch Lsd_83

Lss_84:
    buffer_store_dword v16, v4, s[12:15], s32 offen sc1
    s_branch Lsd_85

Lss_86:
    buffer_store_dwordx2 v[2:3], v7, s[12:15], s33 offen sc1
    s_branch Lsd_87

Lv_89:
    ds_write_b64 v18, v[112:113] offset:0
    ds_write_b64 v18, v[114:115] offset:16
    ds_write_b64 v18, v[116:117] offset:32
    ds_write_b64 v18, v[118:119] offset:48
    ds_read_b64_tr_b16 v[112:113], v19 offset:0
    ds_read_b64_tr_b16 v[114:115], v19 offset:576
    ds_read_b64_tr_b16 v[116:117], v19 offset:1152
    ds_read_b64_tr_b16 v[118:119], v19 offset:1728
    s_waitcnt lgkmcnt(0)
    buffer_store_dwordx4 v[112:115], v20, s[12:15], s33 offen sc1
    buffer_store_dwordx4 v[116:119], v20, s[12:15], s33 offen offset:512 sc1
    s_branch Le_90

Lv_91:
    ds_write_b64 v18, v[120:121] offset:0
    ds_write_b64 v18, v[122:123] offset:16
    ds_write_b64 v18, v[124:125] offset:32
    ds_write_b64 v18, v[126:127] offset:48
    ds_read_b64_tr_b16 v[120:121], v19 offset:0
    ds_read_b64_tr_b16 v[122:123], v19 offset:576
    ds_read_b64_tr_b16 v[124:125], v19 offset:1152
    ds_read_b64_tr_b16 v[126:127], v19 offset:1728
    s_waitcnt lgkmcnt(0)
    buffer_store_dwordx4 v[120:123], v20, s[12:15], s33 offen sc1
    buffer_store_dwordx4 v[124:127], v20, s[12:15], s33 offen offset:512 sc1
    s_branch Le_92

Lv_93:
    ds_write_b64 v18, v[112:113] offset:0
    ds_write_b64 v18, v[114:115] offset:16
    ds_write_b64 v18, v[116:117] offset:32
    ds_write_b64 v18, v[118:119] offset:48
    ds_read_b64_tr_b16 v[112:113], v19 offset:0
    ds_read_b64_tr_b16 v[114:115], v19 offset:576
    ds_read_b64_tr_b16 v[116:117], v19 offset:1152
    ds_read_b64_tr_b16 v[118:119], v19 offset:1728
    s_waitcnt lgkmcnt(0)
    buffer_store_dwordx4 v[112:115], v20, s[12:15], s33 offen sc1
    buffer_store_dwordx4 v[116:119], v20, s[12:15], s33 offen offset:512 sc1
    s_branch Le_94

code_end:
.section .rodata,"a"
.p2align 6
.amdhsa_kernel interleave_layers__mha_block__dense_activation_mish__prompt_kernel
  .amdhsa_next_free_vgpr 256
  .amdhsa_next_free_sgpr 102
  .amdhsa_accum_offset 256
  .amdhsa_group_segment_fixed_size 0
  .amdhsa_kernarg_size 80
  .amdhsa_user_sgpr_count 2
  .amdhsa_user_sgpr_kernarg_segment_ptr 1
  .amdhsa_system_sgpr_workgroup_id_x 1
.end_amdhsa_kernel
```
